```python
import torch

def _softmax(x, axis=-1):
    return torch.softmax(x, dim=axis)
def _gelu(x):
    return torch.nn.functional.gelu(x, approximate="tanh")
def _silu(x):
    return torch.nn.functional.silu(x)
def _sigmoid(x):
    return torch.sigmoid(x)
def _layernorm(x, axis=-1, eps=1e-5):
    m = x.mean(dim=axis, keepdim=True)
    v = x.var(dim=axis, keepdim=True, unbiased=False)
    return (x - m) / torch.sqrt(v + eps)
def _scatter_add(tgt, idx, src, axis=0):
    return tgt.clone().index_add_(axis, idx, src)
def _segment_sum(src, seg, n):
    out = torch.zeros((n,) + src.shape[1:], dtype=src.dtype)
    return out.index_add_(0, seg, src)
def _pad(x, pw):
    flat = tuple(v for pair in reversed(pw) for v in pair)
    return torch.nn.functional.pad(x, flat)

kernel_name = 'concat_heads__compressed_kv_cla__sliding_block_cached__decode'

def setup_inputs():

    _w = (lambda a: (lambda t: t.to(torch.bfloat16) if t.is_floating_point() else t)(torch.as_tensor(a)))
    def _A_setup():
        B, H, Sq, Sk, D, M = 2, 32, 1, 8192, 128, 512
        Dc = 4 * D
        return {
            "x": _w((lambda *s: torch.randn(*s, dtype=torch.bfloat16) * 3.2)(B, Sq, M)),
            "c_kv": _w((lambda *s: torch.randn(*s, dtype=torch.bfloat16) * 0.1)(B, Sk, Dc)),
            "w_q": _w((lambda *s: torch.randn(*s, dtype=torch.bfloat16) * 6.4)(M, H, D) * (M ** -0.5)),
            "w_uk": _w((lambda *s: torch.randn(*s, dtype=torch.bfloat16) * 6.4)(Dc, H, D) * (Dc ** -0.5)),
            "w_uv": _w((lambda *s: torch.randn(*s, dtype=torch.bfloat16) * 0.1)(Dc, H, D) * (Dc ** -0.5)),
            "w_o": _w((lambda *s: torch.randn(*s, dtype=torch.bfloat16) * 0.1)(H, D, M) * ((H * D) ** -0.5)),
        }
    _A_in = _A_setup()

    def _B_setup():
        B, Sq, D = 2, 1, 512
        Hq, Hkv, Sk, Dh = 32, 32, 8192, 128
        assert Hq % Hkv == 0, (Hq, Hkv)
        return {
            "x": _w((lambda *s: torch.randn(*s, dtype=torch.bfloat16) * 1.6)(B, Sq, D)),
            "k_cache": _w((lambda *s: torch.randn(*s, dtype=torch.bfloat16) * 1.6)(B, Hkv, Sk, Dh)),
            "v_cache": _w((lambda *s: torch.randn(*s, dtype=torch.bfloat16) * 0.05)(B, Hkv, Sk, Dh)),
            "wq": _w((lambda *s: torch.randn(*s, dtype=torch.bfloat16) * 1.6)(D, Hq * Dh) * (D ** -0.5)),
            "wo": _w((lambda *s: torch.randn(*s, dtype=torch.bfloat16) * 0.05)(Hq * Dh, D) * ((Hq * Dh) ** -0.5)),
        }
    _B_in = _B_setup()

    return {
        "A_x": _A_in["x"],
        "A_c_kv": _A_in["c_kv"],
        "A_w_q": _A_in["w_q"],
        "A_w_uk": _A_in["w_uk"],
        "A_w_uv": _A_in["w_uv"],
        "A_w_o": _A_in["w_o"],
        "B_x": _B_in["x"],
        "B_k_cache": _B_in["k_cache"],
        "B_v_cache": _B_in["v_cache"],
        "B_wq": _B_in["wq"],
        "B_wo": _B_in["wo"],
    }

def reference(A_x, A_c_kv, A_w_q, A_w_uk, A_w_uv, A_w_o, B_x, B_k_cache, B_v_cache, B_wq, B_wo):
    def _A_ref(x, c_kv, w_q, w_uk, w_uv, w_o):
        B, Sq, M = x.shape[0], x.shape[1], x.shape[2]
        Sk = c_kv.shape[1]
        H, D = w_q.shape[1], w_q.shape[2]
        q = torch.einsum("bqm,mhd->bhqd", x, w_q)
        k = torch.einsum("bkc,chd->bhkd", c_kv, w_uk)
        v = torch.einsum("bkc,chd->bhkd", c_kv, w_uv)
        scores = torch.einsum("bhqd,bhkd->bhqk", q, k) * (D ** -0.5)
        off = Sk - Sq
        qi = torch.arange(Sq)[:, None]
        kj = torch.arange(Sk)[None, :]
        cmask = kj <= (qi + off)
        scores = torch.where(cmask[None, None], scores, -1e9)
        p = _softmax(scores, axis=-1)
        ctx = torch.einsum("bhqk,bhkd->bhqd", p, v)
        return torch.einsum("bhqd,hdm->bqm", ctx, w_o)

    def _B_ref(x, k_cache, v_cache, wq, wo):
        B, Sq, D = x.shape
        Hq, Dh = 32, 128
        Hkv, Sk = k_cache.shape[1], k_cache.shape[2]
        W = min(4096, max(256, Sk // 4))
        rep = Hq // Hkv
        q = (lambda x, *d: x.permute(*d))((x @ wq).reshape(B, Sq, Hq, Dh), 0, 2, 1, 3)
        k = (lambda x, n, axis: torch.repeat_interleave(x, n, dim=axis))(k_cache[:, :, Sk - W:, :], rep, axis=1)
        v = (lambda x, n, axis: torch.repeat_interleave(x, n, dim=axis))(v_cache[:, :, Sk - W:, :], rep, axis=1)
        scores = torch.einsum("bhqd,bhkd->bhqk", q, k) * (Dh ** -0.5)
        p = _softmax(scores, axis=-1)
        o = torch.einsum("bhqk,bhkd->bhqd", p, v)
        return (lambda x, *d: x.permute(*d))(o, 0, 2, 1, 3).reshape(B, Sq, Hq * Dh) @ wo

    a = _A_ref(A_x, A_c_kv, A_w_q, A_w_uk, A_w_uv, A_w_o)
    b = _B_ref(B_x, B_k_cache, B_v_cache, B_wq, B_wo)
    return torch.concatenate([a, b], axis=-1)
```

```asm
; @launch kernel=k0_kernel grid=(256,1,1) block=(256,1,1) lds=16384
; @launch kernel=km_kernel grid=(256,1,1) block=(256,1,1) lds=148608
; @launch kernel=k3_kernel grid=(544,1,1) block=(256,1,1) lds=14336
.amdgcn_target "amdgcn-amd-amdhsa--gfx950"
.text
.globl k0_kernel
.p2align 8
.type k0_kernel,@function
k0_kernel:
    s_cmp_ge_u32 s2, 256
    s_cbranch_scc1 K0_END
    s_load_dwordx2 s[20:21], s[0:1], 104
    s_and_b32 s24, s2, 31
    s_bfe_u32 s25, s2, 0x20005
    s_lshr_b32 s26, s2, 7
    s_cmp_lg_u32 s26, 0
    s_cbranch_scc1 K0_LB
    s_load_dwordx2 s[8:9], s[0:1], 0
    s_load_dwordx2 s[12:13], s[0:1], 16
    s_branch K0_LD
K0_LB:
    s_load_dwordx2 s[8:9], s[0:1], 48
    s_load_dwordx2 s[12:13], s[0:1], 72
K0_LD:
    v_and_b32 v1, 15, v0
    v_lshrrev_b32 v2, 4, v0
    v_lshlrev_b32 v3, 16, v2
    v_lshl_add_u32 v3, v1, 4, v3
    v_lshlrev_b32 v4, 4, v2
    s_lshl_b32 s27, s25, 20
    s_lshl_b32 s28, s24, 8
    s_add_u32 s27, s27, s28
    s_lshl_b32 s28, s25, 8
    s_waitcnt lgkmcnt(0)
    s_mov_b32 s10, 2048
    s_mov_b32 s11, 0x20000
    s_mov_b32 s14, 4194304
    s_mov_b32 s15, 0x20000
    s_mov_b32 s22, 536870912
    s_mov_b32 s23, 0x20000
    buffer_load_dwordx4 v[8:11], v4, s[8:11], s28 offen
    buffer_load_dwordx4 v[12:15], v4, s[8:11], s28 offen offset:1024
    buffer_load_dwordx4 v[40:43], v3, s[12:15], s27 offen nt
    s_add_u32 s27, s27, 8192
    buffer_load_dwordx4 v[44:47], v3, s[12:15], s27 offen nt
    s_add_u32 s27, s27, 8192
    buffer_load_dwordx4 v[48:51], v3, s[12:15], s27 offen nt
    s_add_u32 s27, s27, 8192
    buffer_load_dwordx4 v[52:55], v3, s[12:15], s27 offen nt
    s_add_u32 s27, s27, 8192
    buffer_load_dwordx4 v[56:59], v3, s[12:15], s27 offen nt
    s_add_u32 s27, s27, 8192
    buffer_load_dwordx4 v[60:63], v3, s[12:15], s27 offen nt
    s_add_u32 s27, s27, 8192
    buffer_load_dwordx4 v[64:67], v3, s[12:15], s27 offen nt
    s_add_u32 s27, s27, 8192
    buffer_load_dwordx4 v[68:71], v3, s[12:15], s27 offen nt
    s_add_u32 s27, s27, 8192
    v_mov_b32 v76, 0
    v_mov_b32 v77, 0
    v_mov_b32 v78, 0
    v_mov_b32 v79, 0
    v_lshlrev_b32 v80, 4, v0
    s_lshl_b32 s29, s2, 12
    s_add_u32 s29, s29, 10485760
    buffer_store_dwordx4 v[76:79], v80, s[20:23], s29 offen
    v_lshlrev_b32 v80, 1, v0
    s_lshl_b32 s29, s2, 9
    buffer_store_short v76, v80, s[20:23], s29 offen
    v_mov_b32 v16, 0
    v_mov_b32 v17, 0
    v_mov_b32 v18, 0
    v_mov_b32 v19, 0
    v_mov_b32 v20, 0
    v_mov_b32 v21, 0
    v_mov_b32 v22, 0
    v_mov_b32 v23, 0
    v_mov_b32 v24, 0
    v_mov_b32 v25, 0
    v_mov_b32 v26, 0
    v_mov_b32 v27, 0
    v_mov_b32 v28, 0
    v_mov_b32 v29, 0
    v_mov_b32 v30, 0
    v_mov_b32 v31, 0
    s_waitcnt vmcnt(9)
    v_lshlrev_b32 v6, 16, v8
    v_lshlrev_b32 v7, 16, v12
    v_lshlrev_b32 v32, 16, v40
    v_and_b32 v33, 0xffff0000, v40
    v_lshlrev_b32 v34, 16, v41
    v_and_b32 v35, 0xffff0000, v41
    v_lshlrev_b32 v36, 16, v42
    v_and_b32 v37, 0xffff0000, v42
    v_lshlrev_b32 v38, 16, v43
    v_and_b32 v39, 0xffff0000, v43
    v_fmac_f32 v16, v32, v6
    v_fmac_f32 v24, v32, v7
    v_fmac_f32 v17, v33, v6
    v_fmac_f32 v25, v33, v7
    v_fmac_f32 v18, v34, v6
    v_fmac_f32 v26, v34, v7
    v_fmac_f32 v19, v35, v6
    v_fmac_f32 v27, v35, v7
    v_fmac_f32 v20, v36, v6
    v_fmac_f32 v28, v36, v7
    v_fmac_f32 v21, v37, v6
    v_fmac_f32 v29, v37, v7
    v_fmac_f32 v22, v38, v6
    v_fmac_f32 v30, v38, v7
    v_fmac_f32 v23, v39, v6
    v_fmac_f32 v31, v39, v7
    s_waitcnt vmcnt(8)
    v_and_b32 v6, 0xffff0000, v8
    v_and_b32 v7, 0xffff0000, v12
    v_lshlrev_b32 v32, 16, v44
    v_and_b32 v33, 0xffff0000, v44
    v_lshlrev_b32 v34, 16, v45
    v_and_b32 v35, 0xffff0000, v45
    v_lshlrev_b32 v36, 16, v46
    v_and_b32 v37, 0xffff0000, v46
    v_lshlrev_b32 v38, 16, v47
    v_and_b32 v39, 0xffff0000, v47
    v_fmac_f32 v16, v32, v6
    v_fmac_f32 v24, v32, v7
    v_fmac_f32 v17, v33, v6
    v_fmac_f32 v25, v33, v7
    v_fmac_f32 v18, v34, v6
    v_fmac_f32 v26, v34, v7
    v_fmac_f32 v19, v35, v6
    v_fmac_f32 v27, v35, v7
    v_fmac_f32 v20, v36, v6
    v_fmac_f32 v28, v36, v7
    v_fmac_f32 v21, v37, v6
    v_fmac_f32 v29, v37, v7
    v_fmac_f32 v22, v38, v6
    v_fmac_f32 v30, v38, v7
    v_fmac_f32 v23, v39, v6
    v_fmac_f32 v31, v39, v7
    s_waitcnt vmcnt(7)
    v_lshlrev_b32 v6, 16, v9
    v_lshlrev_b32 v7, 16, v13
    v_lshlrev_b32 v32, 16, v48
    v_and_b32 v33, 0xffff0000, v48
    v_lshlrev_b32 v34, 16, v49
    v_and_b32 v35, 0xffff0000, v49
    v_lshlrev_b32 v36, 16, v50
    v_and_b32 v37, 0xffff0000, v50
    v_lshlrev_b32 v38, 16, v51
    v_and_b32 v39, 0xffff0000, v51
    v_fmac_f32 v16, v32, v6
    v_fmac_f32 v24, v32, v7
    v_fmac_f32 v17, v33, v6
    v_fmac_f32 v25, v33, v7
    v_fmac_f32 v18, v34, v6
    v_fmac_f32 v26, v34, v7
    v_fmac_f32 v19, v35, v6
    v_fmac_f32 v27, v35, v7
    v_fmac_f32 v20, v36, v6
    v_fmac_f32 v28, v36, v7
    v_fmac_f32 v21, v37, v6
    v_fmac_f32 v29, v37, v7
    v_fmac_f32 v22, v38, v6
    v_fmac_f32 v30, v38, v7
    v_fmac_f32 v23, v39, v6
    v_fmac_f32 v31, v39, v7
    s_waitcnt vmcnt(6)
    v_and_b32 v6, 0xffff0000, v9
    v_and_b32 v7, 0xffff0000, v13
    v_lshlrev_b32 v32, 16, v52
    v_and_b32 v33, 0xffff0000, v52
    v_lshlrev_b32 v34, 16, v53
    v_and_b32 v35, 0xffff0000, v53
    v_lshlrev_b32 v36, 16, v54
    v_and_b32 v37, 0xffff0000, v54
    v_lshlrev_b32 v38, 16, v55
    v_and_b32 v39, 0xffff0000, v55
    v_fmac_f32 v16, v32, v6
    v_fmac_f32 v24, v32, v7
    v_fmac_f32 v17, v33, v6
    v_fmac_f32 v25, v33, v7
    v_fmac_f32 v18, v34, v6
    v_fmac_f32 v26, v34, v7
    v_fmac_f32 v19, v35, v6
    v_fmac_f32 v27, v35, v7
    v_fmac_f32 v20, v36, v6
    v_fmac_f32 v28, v36, v7
    v_fmac_f32 v21, v37, v6
    v_fmac_f32 v29, v37, v7
    v_fmac_f32 v22, v38, v6
    v_fmac_f32 v30, v38, v7
    v_fmac_f32 v23, v39, v6
    v_fmac_f32 v31, v39, v7
    s_waitcnt vmcnt(5)
    v_lshlrev_b32 v6, 16, v10
    v_lshlrev_b32 v7, 16, v14
    v_lshlrev_b32 v32, 16, v56
    v_and_b32 v33, 0xffff0000, v56
    v_lshlrev_b32 v34, 16, v57
    v_and_b32 v35, 0xffff0000, v57
    v_lshlrev_b32 v36, 16, v58
    v_and_b32 v37, 0xffff0000, v58
    v_lshlrev_b32 v38, 16, v59
    v_and_b32 v39, 0xffff0000, v59
    v_fmac_f32 v16, v32, v6
    v_fmac_f32 v24, v32, v7
    v_fmac_f32 v17, v33, v6
    v_fmac_f32 v25, v33, v7
    v_fmac_f32 v18, v34, v6
    v_fmac_f32 v26, v34, v7
    v_fmac_f32 v19, v35, v6
    v_fmac_f32 v27, v35, v7
    v_fmac_f32 v20, v36, v6
    v_fmac_f32 v28, v36, v7
    v_fmac_f32 v21, v37, v6
    v_fmac_f32 v29, v37, v7
    v_fmac_f32 v22, v38, v6
    v_fmac_f32 v30, v38, v7
    v_fmac_f32 v23, v39, v6
    v_fmac_f32 v31, v39, v7
    s_waitcnt vmcnt(4)
    v_and_b32 v6, 0xffff0000, v10
    v_and_b32 v7, 0xffff0000, v14
    v_lshlrev_b32 v32, 16, v60
    v_and_b32 v33, 0xffff0000, v60
    v_lshlrev_b32 v34, 16, v61
    v_and_b32 v35, 0xffff0000, v61
    v_lshlrev_b32 v36, 16, v62
    v_and_b32 v37, 0xffff0000, v62
    v_lshlrev_b32 v38, 16, v63
    v_and_b32 v39, 0xffff0000, v63
    v_fmac_f32 v16, v32, v6
    v_fmac_f32 v24, v32, v7
    v_fmac_f32 v17, v33, v6
    v_fmac_f32 v25, v33, v7
    v_fmac_f32 v18, v34, v6
    v_fmac_f32 v26, v34, v7
    v_fmac_f32 v19, v35, v6
    v_fmac_f32 v27, v35, v7
    v_fmac_f32 v20, v36, v6
    v_fmac_f32 v28, v36, v7
    v_fmac_f32 v21, v37, v6
    v_fmac_f32 v29, v37, v7
    v_fmac_f32 v22, v38, v6
    v_fmac_f32 v30, v38, v7
    v_fmac_f32 v23, v39, v6
    v_fmac_f32 v31, v39, v7
    s_waitcnt vmcnt(3)
    v_lshlrev_b32 v6, 16, v11
    v_lshlrev_b32 v7, 16, v15
    v_lshlrev_b32 v32, 16, v64
    v_and_b32 v33, 0xffff0000, v64
    v_lshlrev_b32 v34, 16, v65
    v_and_b32 v35, 0xffff0000, v65
    v_lshlrev_b32 v36, 16, v66
    v_and_b32 v37, 0xffff0000, v66
    v_lshlrev_b32 v38, 16, v67
    v_and_b32 v39, 0xffff0000, v67
    v_fmac_f32 v16, v32, v6
    v_fmac_f32 v24, v32, v7
    v_fmac_f32 v17, v33, v6
    v_fmac_f32 v25, v33, v7
    v_fmac_f32 v18, v34, v6
    v_fmac_f32 v26, v34, v7
    v_fmac_f32 v19, v35, v6
    v_fmac_f32 v27, v35, v7
    v_fmac_f32 v20, v36, v6
    v_fmac_f32 v28, v36, v7
    v_fmac_f32 v21, v37, v6
    v_fmac_f32 v29, v37, v7
    v_fmac_f32 v22, v38, v6
    v_fmac_f32 v30, v38, v7
    v_fmac_f32 v23, v39, v6
    v_fmac_f32 v31, v39, v7
    s_waitcnt vmcnt(2)
    v_and_b32 v6, 0xffff0000, v11
    v_and_b32 v7, 0xffff0000, v15
    v_lshlrev_b32 v32, 16, v68
    v_and_b32 v33, 0xffff0000, v68
    v_lshlrev_b32 v34, 16, v69
    v_and_b32 v35, 0xffff0000, v69
    v_lshlrev_b32 v36, 16, v70
    v_and_b32 v37, 0xffff0000, v70
    v_lshlrev_b32 v38, 16, v71
    v_and_b32 v39, 0xffff0000, v71
    v_fmac_f32 v16, v32, v6
    v_fmac_f32 v24, v32, v7
    v_fmac_f32 v17, v33, v6
    v_fmac_f32 v25, v33, v7
    v_fmac_f32 v18, v34, v6
    v_fmac_f32 v26, v34, v7
    v_fmac_f32 v19, v35, v6
    v_fmac_f32 v27, v35, v7
    v_fmac_f32 v20, v36, v6
    v_fmac_f32 v28, v36, v7
    v_fmac_f32 v21, v37, v6
    v_fmac_f32 v29, v37, v7
    v_fmac_f32 v22, v38, v6
    v_fmac_f32 v30, v38, v7
    v_fmac_f32 v23, v39, v6
    v_fmac_f32 v31, v39, v7
    v_lshlrev_b32 v6, 10, v2
    v_lshl_add_u32 v6, v1, 5, v6
    ds_write_b128 v6, v[16:19]
    ds_write_b128 v6, v[20:23] offset:16
    ds_write_b128 v6, v[24:27] offset:512
    ds_write_b128 v6, v[28:31] offset:528
    s_waitcnt lgkmcnt(0)
    s_barrier
    v_lshlrev_b32 v6, 2, v0
    ds_read_b32 v8, v6 offset:0
    ds_read_b32 v9, v6 offset:1024
    ds_read_b32 v10, v6 offset:2048
    ds_read_b32 v11, v6 offset:3072
    ds_read_b32 v12, v6 offset:4096
    ds_read_b32 v13, v6 offset:5120
    ds_read_b32 v14, v6 offset:6144
    ds_read_b32 v15, v6 offset:7168
    ds_read_b32 v16, v6 offset:8192
    ds_read_b32 v17, v6 offset:9216
    ds_read_b32 v18, v6 offset:10240
    ds_read_b32 v19, v6 offset:11264
    ds_read_b32 v20, v6 offset:12288
    ds_read_b32 v21, v6 offset:13312
    ds_read_b32 v22, v6 offset:14336
    ds_read_b32 v23, v6 offset:15360
    s_waitcnt lgkmcnt(0)
    v_add_f32 v8, v8, v16
    v_add_f32 v9, v9, v17
    v_add_f32 v10, v10, v18
    v_add_f32 v11, v11, v19
    v_add_f32 v12, v12, v20
    v_add_f32 v13, v13, v21
    v_add_f32 v14, v14, v22
    v_add_f32 v15, v15, v23
    v_add_f32 v8, v8, v12
    v_add_f32 v9, v9, v13
    v_add_f32 v10, v10, v14
    v_add_f32 v11, v11, v15
    v_add_f32 v8, v8, v10
    v_add_f32 v9, v9, v11
    v_add_f32 v8, v8, v9
    s_lshl_b32 s27, s26, 17
    s_lshl_b32 s28, s24, 12
    s_add_u32 s27, s27, s28
    s_lshl_b32 s28, s25, 10
    s_add_u32 s27, s27, s28
    s_add_u32 s27, s27, 589824
    buffer_store_dword v8, v6, s[20:23], s27 offen
K0_END:
    s_endpgm
.globl km_kernel
.p2align 8
.type km_kernel,@function
km_kernel:
    s_cmp_ge_u32 s2, 256
    s_cbranch_scc1 KM_END
    s_load_dwordx2 s[8:9], s[0:1], 8
    s_load_dwordx2 s[12:13], s[0:1], 56
    s_load_dwordx2 s[16:17], s[0:1], 64
    s_load_dwordx2 s[20:21], s[0:1], 104
    s_load_dwordx2 s[48:49], s[0:1], 96
    s_and_b32 s3, s2, 7
    s_lshr_b32 s4, s2, 3
    s_lshr_b32 s5, s3, 2
    s_lshl_b32 s24, s4, 1
    s_or_b32 s24, s24, s5
    s_add_u32 s25, s3, s4
    s_and_b32 s25, s25, 3
    v_and_b32 v1, 63, v0
    v_lshrrev_b32 v2, 6, v0
    s_nop 0
    v_readfirstlane_b32 s26, v2
    s_mov_b32 s34, 0x3db504f3
    s_mov_b32 s35, 0x3fb8aa3b
    v_lshlrev_b32 v16, 4, v1
    s_lshl_b32 s27, s26, 13
    v_add_u32 v6, s27, v16
    v_add_u32 v7, 4096, v6
    s_lshl_b32 s30, s24, 21
    s_add_u32 s30, s30, 1572864
    s_load_dwordx2 s[52:53], s[0:1], 24
    v_and_b32 v42, 127, v0
    v_lshlrev_b32 v42, 2, v42
    s_and_b32 s27, s24, 31
    s_lshl_b32 s27, s27, 12
    s_lshr_b32 s28, s24, 5
    s_lshl_b32 s28, s28, 9
    s_add_u32 s27, s27, s28
    s_add_u32 s27, s27, 720896
    s_waitcnt lgkmcnt(0)
    s_mov_b32 s10, 16777216
    s_mov_b32 s11, 0x20000
    s_mov_b32 s14, 134217728
    s_mov_b32 s15, 0x20000
    s_mov_b32 s18, 134217728
    s_mov_b32 s19, 0x20000
    s_mov_b32 s22, 536870912
    s_mov_b32 s23, 0x20000
    s_mov_b32 s50, 256
    s_mov_b32 s51, 0x20000
    s_mov_b32 s54, 4194304
    s_mov_b32 s55, 0x20000
    buffer_load_dword v44, v42, s[20:23], s27 offen offset:0
    buffer_load_dword v45, v42, s[20:23], s27 offen offset:1024
    buffer_load_dword v46, v42, s[20:23], s27 offen offset:2048
    buffer_load_dword v47, v42, s[20:23], s27 offen offset:3072
    s_cmp_ge_u32 s25, 2
    s_cbranch_scc1 KM_BONLY
    s_lshr_b32 s36, s24, 5
    s_and_b32 s37, s24, 31
    s_lshl_b32 s37, s37, 1
    s_add_u32 s37, s37, s25
    s_lshl_b32 s38, s24, 1
    s_add_u32 s38, s38, s25
    s_lshr_b32 s39, s38, 5
    s_and_b32 s38, s38, 31
    s_lshl_b32 s40, s36, 23
    s_lshl_b32 s27, s37, 17
    s_add_u32 s40, s40, s27
    s_lshl_b32 s41, s26, 15
    s_add_u32 s40, s40, s41
    v_lshlrev_b32 v43, 2, v0
    s_lshl_b32 s27, s38, 12
    s_add_u32 s27, s27, 589824
    buffer_load_dword v48, v43, s[20:23], s27 offen offset:0
    buffer_load_dword v49, v43, s[20:23], s27 offen offset:1024
    buffer_load_dword v50, v43, s[20:23], s27 offen offset:2048
    buffer_load_dword v51, v43, s[20:23], s27 offen offset:3072
    v_and_b32 v52, 15, v0
    v_lshrrev_b32 v53, 4, v0
    v_lshlrev_b32 v54, 13, v53
    v_lshl_add_u32 v54, v52, 4, v54
    s_lshl_b32 s27, s39, 20
    s_lshl_b32 s28, s38, 8
    s_add_u32 s27, s27, s28
    buffer_load_dwordx4 v[64:67], v54, s[52:55], s27 offen nt
    s_add_u32 s27, s27, 0x20000
    buffer_load_dwordx4 v[68:71], v54, s[52:55], s27 offen nt
    s_add_u32 s27, s27, 0x20000
    buffer_load_dwordx4 v[72:75], v54, s[52:55], s27 offen nt
    s_add_u32 s27, s27, 0x20000
    buffer_load_dwordx4 v[76:79], v54, s[52:55], s27 offen nt
    s_add_u32 s27, s27, 0x20000
    buffer_load_dwordx4 v[80:83], v54, s[52:55], s27 offen nt
    s_add_u32 s27, s27, 0x20000
    buffer_load_dwordx4 v[84:87], v54, s[52:55], s27 offen nt
    s_add_u32 s27, s27, 0x20000
    buffer_load_dwordx4 v[88:91], v54, s[52:55], s27 offen nt
    s_add_u32 s27, s27, 0x20000
    buffer_load_dwordx4 v[92:95], v54, s[52:55], s27 offen nt
    s_add_u32 s27, s27, 0x20000
    s_add_u32 s42, s40, 0
    buffer_load_dwordx4 a[128:131], v16, s[8:11], s42 offen offset:0 nt
    buffer_load_dwordx4 a[132:135], v16, s[8:11], s42 offen offset:1024 nt
    buffer_load_dwordx4 a[136:139], v16, s[8:11], s42 offen offset:2048 nt
    buffer_load_dwordx4 a[140:143], v16, s[8:11], s42 offen offset:3072 nt
    s_add_u32 s42, s40, 4096
    buffer_load_dwordx4 a[144:147], v16, s[8:11], s42 offen offset:0 nt
    buffer_load_dwordx4 a[148:151], v16, s[8:11], s42 offen offset:1024 nt
    s_waitcnt vmcnt(14)
    v_add_f32 v44, v44, v45
    v_add_f32 v46, v46, v47
    v_add_f32 v48, v48, v49
    v_add_f32 v50, v50, v51
    v_add_f32 v44, v44, v46
    v_add_f32 v48, v48, v50
    v_cvt_pk_bf16_f32 v44, v44, v44
    v_cvt_pk_bf16_f32 v48, v48, v48
    v_lshrrev_b32 v42, 1, v42
    v_add_u32 v42, 134144, v42
    ds_write_b16 v42, v44
    v_lshlrev_b32 v43, 1, v0
    v_add_u32 v43, 132096, v43
    ds_write_b16 v43, v48
    buffer_load_dwordx4 a[152:155], v16, s[8:11], s42 offen offset:2048 nt
    buffer_load_dwordx4 a[156:159], v16, s[8:11], s42 offen offset:3072 nt
    s_waitcnt lgkmcnt(0)
    s_barrier
    v_lshlrev_b32 v43, 4, v52
    v_add_u32 v43, 132096, v43
    ds_read_b128 v[8:11], v43
    ds_read_b128 v[12:15], v43 offset:256
    ds_read_b128 v[2:5], v43 offset:2048
    s_waitcnt vmcnt(8) lgkmcnt(0)
    v_dot2_f32_bf16 v24, v64, v8, 0
    v_dot2_f32_bf16 v25, v64, v12, 0
    v_dot2_f32_bf16 v26, v68, v8, 0
    v_dot2_f32_bf16 v27, v68, v12, 0
    v_dot2_f32_bf16 v28, v72, v8, 0
    v_dot2_f32_bf16 v29, v72, v12, 0
    v_dot2_f32_bf16 v30, v76, v8, 0
    v_dot2_f32_bf16 v31, v76, v12, 0
    v_dot2_f32_bf16 v32, v80, v8, 0
    v_dot2_f32_bf16 v33, v80, v12, 0
    v_dot2_f32_bf16 v34, v84, v8, 0
    v_dot2_f32_bf16 v35, v84, v12, 0
    v_dot2_f32_bf16 v36, v88, v8, 0
    v_dot2_f32_bf16 v37, v88, v12, 0
    v_dot2_f32_bf16 v38, v92, v8, 0
    v_dot2_f32_bf16 v39, v92, v12, 0
    v_dot2_f32_bf16 v24, v65, v9, v24
    v_dot2_f32_bf16 v25, v65, v13, v25
    v_dot2_f32_bf16 v26, v69, v9, v26
    v_dot2_f32_bf16 v27, v69, v13, v27
    v_dot2_f32_bf16 v28, v73, v9, v28
    v_dot2_f32_bf16 v29, v73, v13, v29
    v_dot2_f32_bf16 v30, v77, v9, v30
    v_dot2_f32_bf16 v31, v77, v13, v31
    v_dot2_f32_bf16 v32, v81, v9, v32
    v_dot2_f32_bf16 v33, v81, v13, v33
    v_dot2_f32_bf16 v34, v85, v9, v34
    v_dot2_f32_bf16 v35, v85, v13, v35
    v_dot2_f32_bf16 v36, v89, v9, v36
    v_dot2_f32_bf16 v37, v89, v13, v37
    v_dot2_f32_bf16 v38, v93, v9, v38
    v_dot2_f32_bf16 v39, v93, v13, v39
    v_dot2_f32_bf16 v24, v66, v10, v24
    v_dot2_f32_bf16 v25, v66, v14, v25
    v_dot2_f32_bf16 v26, v70, v10, v26
    v_dot2_f32_bf16 v27, v70, v14, v27
    v_dot2_f32_bf16 v28, v74, v10, v28
    v_dot2_f32_bf16 v29, v74, v14, v29
    v_dot2_f32_bf16 v30, v78, v10, v30
    v_dot2_f32_bf16 v31, v78, v14, v31
    v_dot2_f32_bf16 v32, v82, v10, v32
    v_dot2_f32_bf16 v33, v82, v14, v33
    v_dot2_f32_bf16 v34, v86, v10, v34
    v_dot2_f32_bf16 v35, v86, v14, v35
    v_dot2_f32_bf16 v36, v90, v10, v36
    v_dot2_f32_bf16 v37, v90, v14, v37
    v_dot2_f32_bf16 v38, v94, v10, v38
    v_dot2_f32_bf16 v39, v94, v14, v39
    v_dot2_f32_bf16 v24, v67, v11, v24
    v_dot2_f32_bf16 v25, v67, v15, v25
    v_dot2_f32_bf16 v26, v71, v11, v26
    v_dot2_f32_bf16 v27, v71, v15, v27
    v_dot2_f32_bf16 v28, v75, v11, v28
    v_dot2_f32_bf16 v29, v75, v15, v29
    v_dot2_f32_bf16 v30, v79, v11, v30
    v_dot2_f32_bf16 v31, v79, v15, v31
    v_dot2_f32_bf16 v32, v83, v11, v32
    v_dot2_f32_bf16 v33, v83, v15, v33
    v_dot2_f32_bf16 v34, v87, v11, v34
    v_dot2_f32_bf16 v35, v87, v15, v35
    v_dot2_f32_bf16 v36, v91, v11, v36
    v_dot2_f32_bf16 v37, v91, v15, v37
    v_dot2_f32_bf16 v38, v95, v11, v38
    v_dot2_f32_bf16 v39, v95, v15, v39
    s_nop 3
    v_add_f32_dpp v24, v24, v24 row_ror:8 row_mask:0xf bank_mask:0xf
    v_add_f32_dpp v25, v25, v25 row_ror:8 row_mask:0xf bank_mask:0xf
    v_add_f32_dpp v26, v26, v26 row_ror:8 row_mask:0xf bank_mask:0xf
    v_add_f32_dpp v27, v27, v27 row_ror:8 row_mask:0xf bank_mask:0xf
    v_add_f32_dpp v28, v28, v28 row_ror:8 row_mask:0xf bank_mask:0xf
    v_add_f32_dpp v29, v29, v29 row_ror:8 row_mask:0xf bank_mask:0xf
    v_add_f32_dpp v30, v30, v30 row_ror:8 row_mask:0xf bank_mask:0xf
    v_add_f32_dpp v31, v31, v31 row_ror:8 row_mask:0xf bank_mask:0xf
    v_add_f32_dpp v32, v32, v32 row_ror:8 row_mask:0xf bank_mask:0xf
    v_add_f32_dpp v33, v33, v33 row_ror:8 row_mask:0xf bank_mask:0xf
    v_add_f32_dpp v34, v34, v34 row_ror:8 row_mask:0xf bank_mask:0xf
    v_add_f32_dpp v35, v35, v35 row_ror:8 row_mask:0xf bank_mask:0xf
    v_add_f32_dpp v36, v36, v36 row_ror:8 row_mask:0xf bank_mask:0xf
    v_add_f32_dpp v37, v37, v37 row_ror:8 row_mask:0xf bank_mask:0xf
    v_add_f32_dpp v38, v38, v38 row_ror:8 row_mask:0xf bank_mask:0xf
    v_add_f32_dpp v39, v39, v39 row_ror:8 row_mask:0xf bank_mask:0xf
    v_add_f32_dpp v24, v24, v24 row_ror:4 row_mask:0xf bank_mask:0xf
    v_add_f32_dpp v25, v25, v25 row_ror:4 row_mask:0xf bank_mask:0xf
    v_add_f32_dpp v26, v26, v26 row_ror:4 row_mask:0xf bank_mask:0xf
    v_add_f32_dpp v27, v27, v27 row_ror:4 row_mask:0xf bank_mask:0xf
    v_add_f32_dpp v28, v28, v28 row_ror:4 row_mask:0xf bank_mask:0xf
    v_add_f32_dpp v29, v29, v29 row_ror:4 row_mask:0xf bank_mask:0xf
    v_add_f32_dpp v30, v30, v30 row_ror:4 row_mask:0xf bank_mask:0xf
    v_add_f32_dpp v31, v31, v31 row_ror:4 row_mask:0xf bank_mask:0xf
    v_add_f32_dpp v32, v32, v32 row_ror:4 row_mask:0xf bank_mask:0xf
    v_add_f32_dpp v33, v33, v33 row_ror:4 row_mask:0xf bank_mask:0xf
    v_add_f32_dpp v34, v34, v34 row_ror:4 row_mask:0xf bank_mask:0xf
    v_add_f32_dpp v35, v35, v35 row_ror:4 row_mask:0xf bank_mask:0xf
    v_add_f32_dpp v36, v36, v36 row_ror:4 row_mask:0xf bank_mask:0xf
    v_add_f32_dpp v37, v37, v37 row_ror:4 row_mask:0xf bank_mask:0xf
    v_add_f32_dpp v38, v38, v38 row_ror:4 row_mask:0xf bank_mask:0xf
    v_add_f32_dpp v39, v39, v39 row_ror:4 row_mask:0xf bank_mask:0xf
    v_add_f32_dpp v24, v24, v24 row_ror:2 row_mask:0xf bank_mask:0xf
    v_add_f32_dpp v25, v25, v25 row_ror:2 row_mask:0xf bank_mask:0xf
    v_add_f32_dpp v26, v26, v26 row_ror:2 row_mask:0xf bank_mask:0xf
    v_add_f32_dpp v27, v27, v27 row_ror:2 row_mask:0xf bank_mask:0xf
    v_add_f32_dpp v28, v28, v28 row_ror:2 row_mask:0xf bank_mask:0xf
    v_add_f32_dpp v29, v29, v29 row_ror:2 row_mask:0xf bank_mask:0xf
    v_add_f32_dpp v30, v30, v30 row_ror:2 row_mask:0xf bank_mask:0xf
    v_add_f32_dpp v31, v31, v31 row_ror:2 row_mask:0xf bank_mask:0xf
    v_add_f32_dpp v32, v32, v32 row_ror:2 row_mask:0xf bank_mask:0xf
    v_add_f32_dpp v33, v33, v33 row_ror:2 row_mask:0xf bank_mask:0xf
    v_add_f32_dpp v34, v34, v34 row_ror:2 row_mask:0xf bank_mask:0xf
    v_add_f32_dpp v35, v35, v35 row_ror:2 row_mask:0xf bank_mask:0xf
    v_add_f32_dpp v36, v36, v36 row_ror:2 row_mask:0xf bank_mask:0xf
    v_add_f32_dpp v37, v37, v37 row_ror:2 row_mask:0xf bank_mask:0xf
    v_add_f32_dpp v38, v38, v38 row_ror:2 row_mask:0xf bank_mask:0xf
    v_add_f32_dpp v39, v39, v39 row_ror:2 row_mask:0xf bank_mask:0xf
    v_add_f32_dpp v24, v24, v24 row_ror:1 row_mask:0xf bank_mask:0xf
    v_add_f32_dpp v25, v25, v25 row_ror:1 row_mask:0xf bank_mask:0xf
    v_add_f32_dpp v26, v26, v26 row_ror:1 row_mask:0xf bank_mask:0xf
    v_add_f32_dpp v27, v27, v27 row_ror:1 row_mask:0xf bank_mask:0xf
    v_add_f32_dpp v28, v28, v28 row_ror:1 row_mask:0xf bank_mask:0xf
    v_add_f32_dpp v29, v29, v29 row_ror:1 row_mask:0xf bank_mask:0xf
    v_add_f32_dpp v30, v30, v30 row_ror:1 row_mask:0xf bank_mask:0xf
    v_add_f32_dpp v31, v31, v31 row_ror:1 row_mask:0xf bank_mask:0xf
    v_add_f32_dpp v32, v32, v32 row_ror:1 row_mask:0xf bank_mask:0xf
    v_add_f32_dpp v33, v33, v33 row_ror:1 row_mask:0xf bank_mask:0xf
    v_add_f32_dpp v34, v34, v34 row_ror:1 row_mask:0xf bank_mask:0xf
    v_add_f32_dpp v35, v35, v35 row_ror:1 row_mask:0xf bank_mask:0xf
    v_add_f32_dpp v36, v36, v36 row_ror:1 row_mask:0xf bank_mask:0xf
    v_add_f32_dpp v37, v37, v37 row_ror:1 row_mask:0xf bank_mask:0xf
    v_add_f32_dpp v38, v38, v38 row_ror:1 row_mask:0xf bank_mask:0xf
    v_add_f32_dpp v39, v39, v39 row_ror:1 row_mask:0xf bank_mask:0xf
    v_lshlrev_b32 v43, 2, v53
    v_add_u32 v43, 132608, v43
    ds_write_b32 v43, v24 offset:0
    ds_write_b32 v43, v25 offset:512
    ds_write_b32 v43, v26 offset:64
    ds_write_b32 v43, v27 offset:576
    ds_write_b32 v43, v28 offset:128
    ds_write_b32 v43, v29 offset:640
    ds_write_b32 v43, v30 offset:192
    ds_write_b32 v43, v31 offset:704
    ds_write_b32 v43, v32 offset:256
    ds_write_b32 v43, v33 offset:768
    ds_write_b32 v43, v34 offset:320
    ds_write_b32 v43, v35 offset:832
    ds_write_b32 v43, v36 offset:384
    ds_write_b32 v43, v37 offset:896
    ds_write_b32 v43, v38 offset:448
    ds_write_b32 v43, v39 offset:960
    s_waitcnt lgkmcnt(0)
    s_barrier
    v_cmp_gt_u32 vcc, 32, v0
    s_and_saveexec_b64 s[56:57], vcc
    s_cbranch_execz KM_QDONE
    v_lshlrev_b32 v43, 5, v0
    v_add_u32 v43, 132608, v43
    ds_read_b128 v[8:11], v43
    ds_read_b128 v[12:15], v43 offset:16
    s_waitcnt lgkmcnt(0)
    v_cvt_pk_bf16_f32 v24, v8, v9
    v_or_b32 v24, 1, v24
    v_lshlrev_b32 v32, 16, v24
    v_and_b32 v33, 0xffff0000, v24
    v_sub_f32 v32, v8, v32
    v_sub_f32 v33, v9, v33
    v_cvt_pk_bf16_f32 v28, v32, v33
    v_or_b32 v28, 1, v28
    v_cvt_pk_bf16_f32 v25, v10, v11
    v_or_b32 v25, 1, v25
    v_lshlrev_b32 v32, 16, v25
    v_and_b32 v33, 0xffff0000, v25
    v_sub_f32 v32, v10, v32
    v_sub_f32 v33, v11, v33
    v_cvt_pk_bf16_f32 v29, v32, v33
    v_or_b32 v29, 1, v29
    v_cvt_pk_bf16_f32 v26, v12, v13
    v_or_b32 v26, 1, v26
    v_lshlrev_b32 v32, 16, v26
    v_and_b32 v33, 0xffff0000, v26
    v_sub_f32 v32, v12, v32
    v_sub_f32 v33, v13, v33
    v_cvt_pk_bf16_f32 v30, v32, v33
    v_or_b32 v30, 1, v30
    v_cvt_pk_bf16_f32 v27, v14, v15
    v_or_b32 v27, 1, v27
    v_lshlrev_b32 v32, 16, v27
    v_and_b32 v33, 0xffff0000, v27
    v_sub_f32 v32, v14, v32
    v_sub_f32 v33, v15, v33
    v_cvt_pk_bf16_f32 v31, v32, v33
    v_or_b32 v31, 1, v31
    v_lshrrev_b32 v43, 4, v0
    v_and_b32 v32, 15, v0
    v_lshrrev_b32 v33, 1, v32
    v_and_b32 v32, 1, v32
    v_lshlrev_b32 v43, 15, v43
    v_lshl_add_u32 v43, v33, 10, v43
    v_lshl_add_u32 v43, v32, 9, v43
    s_lshl_b32 s27, s39, 13
    s_lshl_b32 s28, s38, 4
    s_add_u32 s27, s27, s28
    buffer_store_dwordx4 v[24:27], v43, s[20:23], s27 offen sc1
    s_add_u32 s27, s27, 65536
    buffer_store_dwordx4 v[28:31], v43, s[20:23], s27 offen sc1
KM_QDONE:
    s_mov_b64 exec, s[56:57]
    s_add_u32 s42, s40, 8192
    buffer_load_dwordx4 a[160:163], v16, s[8:11], s42 offen offset:0 nt
    buffer_load_dwordx4 a[164:167], v16, s[8:11], s42 offen offset:1024 nt
    buffer_load_dwordx4 a[168:171], v16, s[8:11], s42 offen offset:2048 nt
    buffer_load_dwordx4 a[172:175], v16, s[8:11], s42 offen offset:3072 nt
    s_add_u32 s42, s40, 12288
    buffer_load_dwordx4 a[176:179], v16, s[8:11], s42 offen offset:0 nt
    buffer_load_dwordx4 a[180:183], v16, s[8:11], s42 offen offset:1024 nt
    buffer_load_dwordx4 a[184:187], v16, s[8:11], s42 offen offset:2048 nt
    buffer_load_dwordx4 a[188:191], v16, s[8:11], s42 offen offset:3072 nt
    s_add_u32 s42, s40, 16384
    buffer_load_dwordx4 a[192:195], v16, s[8:11], s42 offen offset:0 nt
    buffer_load_dwordx4 a[196:199], v16, s[8:11], s42 offen offset:1024 nt
    buffer_load_dwordx4 a[200:203], v16, s[8:11], s42 offen offset:2048 nt
    buffer_load_dwordx4 a[204:207], v16, s[8:11], s42 offen offset:3072 nt
    s_add_u32 s42, s40, 20480
    buffer_load_dwordx4 a[208:211], v16, s[8:11], s42 offen offset:0 nt
    buffer_load_dwordx4 a[212:215], v16, s[8:11], s42 offen offset:1024 nt
    buffer_load_dwordx4 a[216:219], v16, s[8:11], s42 offen offset:2048 nt
    buffer_load_dwordx4 a[220:223], v16, s[8:11], s42 offen offset:3072 nt
    s_add_u32 s42, s40, 24576
    buffer_load_dwordx4 a[224:227], v16, s[8:11], s42 offen offset:0 nt
    buffer_load_dwordx4 a[228:231], v16, s[8:11], s42 offen offset:1024 nt
    buffer_load_dwordx4 a[232:235], v16, s[8:11], s42 offen offset:2048 nt
    buffer_load_dwordx4 a[236:239], v16, s[8:11], s42 offen offset:3072 nt
    s_add_u32 s42, s40, 28672
    buffer_load_dwordx4 a[240:243], v16, s[8:11], s42 offen offset:0 nt
    buffer_load_dwordx4 a[244:247], v16, s[8:11], s42 offen offset:1024 nt
    buffer_load_dwordx4 a[248:251], v16, s[8:11], s42 offen offset:2048 nt
    buffer_load_dwordx4 a[252:255], v16, s[8:11], s42 offen offset:3072 nt
    v_and_b32 v56, 31, v1
    v_lshrrev_b32 v57, 5, v1
    v_and_b32 v58, 3, v1
    v_lshlrev_b32 v58, 2, v58
    v_bfe_u32 v59, v1, 2, 2
    v_or_b32 v58, v58, v59
    v_xor_b32 v58, v58, v57
    v_lshlrev_b32 v58, 4, v58
    v_xor_b32 v28, 0, v58
    v_xor_b32 v29, 32, v58
    v_xor_b32 v30, 64, v58
    v_xor_b32 v31, 96, v58
    v_xor_b32 v32, 128, v58
    v_xor_b32 v33, 160, v58
    v_xor_b32 v34, 192, v58
    v_xor_b32 v35, 224, v58
    v_lshlrev_b32 v59, 10, v56
    s_lshl_b32 s27, s26, 8
    v_add_u32 v59, s27, v59
    s_add_u32 s27, s26, 0
    s_and_b32 s27, s27, 3
    s_lshl_b32 s27, s27, 15
    v_add_u32 v24, s27, v59
    s_sub_u32 s27, s26, 0
    s_and_b32 s27, s27, 3
    s_lshl_b32 s27, s27, 12
    s_add_u32 s27, s27, 132096
    v_add_u32 v36, s27, v16
    s_add_u32 s27, s26, 1
    s_and_b32 s27, s27, 3
    s_lshl_b32 s27, s27, 15
    v_add_u32 v25, s27, v59
    s_sub_u32 s27, s26, 1
    s_and_b32 s27, s27, 3
    s_lshl_b32 s27, s27, 12
    s_add_u32 s27, s27, 132096
    v_add_u32 v37, s27, v16
    s_add_u32 s27, s26, 2
    s_and_b32 s27, s27, 3
    s_lshl_b32 s27, s27, 15
    v_add_u32 v26, s27, v59
    s_sub_u32 s27, s26, 2
    s_and_b32 s27, s27, 3
    s_lshl_b32 s27, s27, 12
    s_add_u32 s27, s27, 132096
    v_add_u32 v38, s27, v16
    s_add_u32 s27, s26, 3
    s_and_b32 s27, s27, 3
    s_lshl_b32 s27, s27, 15
    v_add_u32 v27, s27, v59
    s_sub_u32 s27, s26, 3
    s_and_b32 s27, s27, 3
    s_lshl_b32 s27, s27, 12
    s_add_u32 s27, s27, 132096
    v_add_u32 v39, s27, v16
    v_lshrrev_b32 v60, 4, v1
    v_lshrrev_b32 v61, 5, v1
    v_bfe_u32 v62, v1, 2, 2
    v_and_b32 v63, 3, v1
    v_and_b32 v64, 1, v60
    v_lshlrev_b32 v64, 1, v64
    v_lshrrev_b32 v65, 1, v63
    v_add_u32 v64, v64, v65
    v_lshl_or_b32 v65, v62, 2, v61
    v_xor_b32 v64, v64, v65
    v_lshlrev_b32 v64, 4, v64
    v_and_b32 v65, 1, v63
    v_lshl_add_u32 v64, v65, 3, v64
    v_lshl_add_u32 v65, v61, 2, v62
    v_lshl_add_u32 v64, v65, 10, v64
    s_lshl_b32 s27, s26, 8
    v_add_u32 v64, s27, v64
    v_xor_b32 v40, 0, v64
    v_add_u32 v48, 0x10000, v40
    v_xor_b32 v41, 32, v64
    v_add_u32 v49, 0x10000, v41
    v_xor_b32 v42, 64, v64
    v_add_u32 v50, 0x10000, v42
    v_xor_b32 v43, 96, v64
    v_add_u32 v51, 0x10000, v43
    v_xor_b32 v44, 128, v64
    v_add_u32 v52, 0x10000, v44
    v_xor_b32 v45, 160, v64
    v_add_u32 v53, 0x10000, v45
    v_xor_b32 v46, 192, v64
    v_add_u32 v54, 0x10000, v46
    v_xor_b32 v47, 224, v64
    v_add_u32 v55, 0x10000, v47
    v_lshlrev_b32 v18, 2, v56
    v_add_u32 v18, 131072, v18
    s_lshl_b32 s27, s26, 7
    v_add_u32 v17, s27, v18
    v_add_u32 v20, 132096, v16
    s_lshl_b32 s27, s26, 11
    v_add_u32 v19, s27, v20
    v_mov_b32 v8, 0xff800000
    v_mov_b32 v9, 0
    v_add_u32 v12, s41, v16
    v_xor_b32 v13, 0, v12
    s_waitcnt vmcnt(31)
    ds_write_b128 v13, a[128:131] offset:0
    v_xor_b32 v14, 64, v12
    s_waitcnt vmcnt(30)
    ds_write_b128 v14, a[132:135] offset:1024
    v_xor_b32 v13, 128, v12
    s_waitcnt vmcnt(29)
    ds_write_b128 v13, a[136:139] offset:2048
    v_xor_b32 v14, 192, v12
    s_waitcnt vmcnt(28)
    ds_write_b128 v14, a[140:143] offset:3072
    v_xor_b32 v13, 16, v12
    s_waitcnt vmcnt(27)
    ds_write_b128 v13, a[144:147] offset:4096
    v_xor_b32 v14, 80, v12
    s_waitcnt vmcnt(26)
    ds_write_b128 v14, a[148:151] offset:5120
    v_xor_b32 v13, 144, v12
    s_waitcnt vmcnt(25)
    ds_write_b128 v13, a[152:155] offset:6144
    v_xor_b32 v14, 208, v12
    s_waitcnt vmcnt(24)
    ds_write_b128 v14, a[156:159] offset:7168
    v_xor_b32 v13, 32, v12
    s_waitcnt vmcnt(23)
    ds_write_b128 v13, a[160:163] offset:8192
    v_xor_b32 v14, 96, v12
    s_waitcnt vmcnt(22)
    ds_write_b128 v14, a[164:167] offset:9216
    v_xor_b32 v13, 160, v12
    s_waitcnt vmcnt(21)
    ds_write_b128 v13, a[168:171] offset:10240
    v_xor_b32 v14, 224, v12
    s_waitcnt vmcnt(20)
    ds_write_b128 v14, a[172:175] offset:11264
    v_xor_b32 v13, 48, v12
    s_waitcnt vmcnt(19)
    ds_write_b128 v13, a[176:179] offset:12288
    v_xor_b32 v14, 112, v12
    s_waitcnt vmcnt(18)
    ds_write_b128 v14, a[180:183] offset:13312
    v_xor_b32 v13, 176, v12
    s_waitcnt vmcnt(17)
    ds_write_b128 v13, a[184:187] offset:14336
    v_xor_b32 v14, 240, v12
    s_waitcnt vmcnt(16)
    ds_write_b128 v14, a[188:191] offset:15360
    v_xor_b32 v13, 0, v12
    s_waitcnt vmcnt(15)
    ds_write_b128 v13, a[192:195] offset:16384
    v_xor_b32 v14, 64, v12
    s_waitcnt vmcnt(14)
    ds_write_b128 v14, a[196:199] offset:17408
    v_xor_b32 v13, 128, v12
    s_waitcnt vmcnt(13)
    ds_write_b128 v13, a[200:203] offset:18432
    v_xor_b32 v14, 192, v12
    s_waitcnt vmcnt(12)
    ds_write_b128 v14, a[204:207] offset:19456
    v_xor_b32 v13, 16, v12
    s_waitcnt vmcnt(11)
    ds_write_b128 v13, a[208:211] offset:20480
    v_xor_b32 v14, 80, v12
    s_waitcnt vmcnt(10)
    ds_write_b128 v14, a[212:215] offset:21504
    v_xor_b32 v13, 144, v12
    s_waitcnt vmcnt(9)
    ds_write_b128 v13, a[216:219] offset:22528
    v_xor_b32 v14, 208, v12
    s_waitcnt vmcnt(8)
    ds_write_b128 v14, a[220:223] offset:23552
    v_xor_b32 v13, 32, v12
    s_waitcnt vmcnt(7)
    ds_write_b128 v13, a[224:227] offset:24576
    v_xor_b32 v14, 96, v12
    s_waitcnt vmcnt(6)
    ds_write_b128 v14, a[228:231] offset:25600
    v_xor_b32 v13, 160, v12
    s_waitcnt vmcnt(5)
    ds_write_b128 v13, a[232:235] offset:26624
    v_xor_b32 v14, 224, v12
    s_waitcnt vmcnt(4)
    ds_write_b128 v14, a[236:239] offset:27648
    v_xor_b32 v13, 48, v12
    s_waitcnt vmcnt(3)
    ds_write_b128 v13, a[240:243] offset:28672
    v_xor_b32 v14, 112, v12
    s_waitcnt vmcnt(2)
    ds_write_b128 v14, a[244:247] offset:29696
    v_xor_b32 v13, 176, v12
    s_waitcnt vmcnt(1)
    ds_write_b128 v13, a[248:251] offset:30720
    v_xor_b32 v14, 240, v12
    s_waitcnt vmcnt(0)
    ds_write_b128 v14, a[252:255] offset:31744
    s_waitcnt lgkmcnt(0)
    s_lshl_b32 s27, s36, 15
    s_lshl_b32 s28, s26, 13
    s_add_u32 s27, s27, s28
    s_mov_b32 s44, 0x80000
KM_QPOLL:
    s_add_u32 s28, s27, 0
    buffer_load_dwordx4 v[192:195], v16, s[20:23], s28 offen offset:0 sc1
    buffer_load_dwordx4 v[196:199], v16, s[20:23], s28 offen offset:1024 sc1
    buffer_load_dwordx4 v[200:203], v16, s[20:23], s28 offen offset:2048 sc1
    buffer_load_dwordx4 v[204:207], v16, s[20:23], s28 offen offset:3072 sc1
    s_add_u32 s28, s27, 4096
    buffer_load_dwordx4 v[208:211], v16, s[20:23], s28 offen offset:0 sc1
    buffer_load_dwordx4 v[212:215], v16, s[20:23], s28 offen offset:1024 sc1
    buffer_load_dwordx4 v[216:219], v16, s[20:23], s28 offen offset:2048 sc1
    buffer_load_dwordx4 v[220:223], v16, s[20:23], s28 offen offset:3072 sc1
    s_add_u32 s28, s27, 65536
    buffer_load_dwordx4 v[224:227], v16, s[20:23], s28 offen offset:0 sc1
    buffer_load_dwordx4 v[228:231], v16, s[20:23], s28 offen offset:1024 sc1
    buffer_load_dwordx4 v[232:235], v16, s[20:23], s28 offen offset:2048 sc1
    buffer_load_dwordx4 v[236:239], v16, s[20:23], s28 offen offset:3072 sc1
    s_add_u32 s28, s27, 69632
    buffer_load_dwordx4 v[240:243], v16, s[20:23], s28 offen offset:0 sc1
    buffer_load_dwordx4 v[244:247], v16, s[20:23], s28 offen offset:1024 sc1
    buffer_load_dwordx4 v[248:251], v16, s[20:23], s28 offen offset:2048 sc1
    buffer_load_dwordx4 v[252:255], v16, s[20:23], s28 offen offset:3072 sc1
    s_waitcnt vmcnt(0)
    v_and_b32 v11, v192, v193
    v_and_b32 v11, v11, v194
    v_and_b32 v11, v11, v195
    v_and_b32 v11, v11, v196
    v_and_b32 v11, v11, v197
    v_and_b32 v11, v11, v198
    v_and_b32 v11, v11, v199
    v_and_b32 v11, v11, v200
    v_and_b32 v11, v11, v201
    v_and_b32 v11, v11, v202
    v_and_b32 v11, v11, v203
    v_and_b32 v11, v11, v204
    v_and_b32 v11, v11, v205
    v_and_b32 v11, v11, v206
    v_and_b32 v11, v11, v207
    v_and_b32 v11, v11, v208
    v_and_b32 v11, v11, v209
    v_and_b32 v11, v11, v210
    v_and_b32 v11, v11, v211
    v_and_b32 v11, v11, v212
    v_and_b32 v11, v11, v213
    v_and_b32 v11, v11, v214
    v_and_b32 v11, v11, v215
    v_and_b32 v11, v11, v216
    v_and_b32 v11, v11, v217
    v_and_b32 v11, v11, v218
    v_and_b32 v11, v11, v219
    v_and_b32 v11, v11, v220
    v_and_b32 v11, v11, v221
    v_and_b32 v11, v11, v222
    v_and_b32 v11, v11, v223
    v_and_b32 v11, v11, v224
    v_and_b32 v11, v11, v225
    v_and_b32 v11, v11, v226
    v_and_b32 v11, v11, v227
    v_and_b32 v11, v11, v228
    v_and_b32 v11, v11, v229
    v_and_b32 v11, v11, v230
    v_and_b32 v11, v11, v231
    v_and_b32 v11, v11, v232
    v_and_b32 v11, v11, v233
    v_and_b32 v11, v11, v234
    v_and_b32 v11, v11, v235
    v_and_b32 v11, v11, v236
    v_and_b32 v11, v11, v237
    v_and_b32 v11, v11, v238
    v_and_b32 v11, v11, v239
    v_and_b32 v11, v11, v240
    v_and_b32 v11, v11, v241
    v_and_b32 v11, v11, v242
    v_and_b32 v11, v11, v243
    v_and_b32 v11, v11, v244
    v_and_b32 v11, v11, v245
    v_and_b32 v11, v11, v246
    v_and_b32 v11, v11, v247
    v_and_b32 v11, v11, v248
    v_and_b32 v11, v11, v249
    v_and_b32 v11, v11, v250
    v_and_b32 v11, v11, v251
    v_and_b32 v11, v11, v252
    v_and_b32 v11, v11, v253
    v_and_b32 v11, v11, v254
    v_and_b32 v11, v11, v255
    v_and_b32 v11, 1, v11
    v_cmp_eq_u32 vcc, 0, v11
    s_cbranch_vccz KM_QOK
    s_sleep 1
    s_sub_u32 s44, s44, 1
    s_cmp_lg_u32 s44, 0
    s_cbranch_scc1 KM_QPOLL
KM_QOK:
    s_lshl_b32 s27, s25, 16
    s_add_u32 s31, s30, s27
    s_add_u32 s31, s31, 393216
    s_add_u32 s33, s31, 32768
    s_barrier
    v_add_u32 v22, v24, v28
    ds_read_b128 v[72:75], v22
    v_add_u32 v23, v24, v29
    ds_read_b128 v[76:79], v23
    v_add_u32 v22, v24, v30
    ds_read_b128 v[80:83], v22
    v_add_u32 v23, v24, v31
    ds_read_b128 v[84:87], v23
    v_add_u32 v22, v24, v32
    ds_read_b128 v[88:91], v22
    v_add_u32 v23, v24, v33
    ds_read_b128 v[92:95], v23
    v_add_u32 v22, v24, v34
    ds_read_b128 v[96:99], v22
    v_add_u32 v23, v24, v35
    ds_read_b128 v[100:103], v23
    s_waitcnt lgkmcnt(7)
    v_mfma_f32_32x32x16_bf16 a[64:79], v[72:75], v[192:195], 0
    v_mfma_f32_32x32x16_bf16 a[64:79], v[72:75], v[224:227], a[64:79]
    v_add_u32 v22, v25, v28
    ds_read_b128 v[72:75], v22
    s_waitcnt lgkmcnt(7)
    v_mfma_f32_32x32x16_bf16 a[64:79], v[76:79], v[196:199], a[64:79]
    v_mfma_f32_32x32x16_bf16 a[64:79], v[76:79], v[228:231], a[64:79]
    v_add_u32 v23, v25, v29
    ds_read_b128 v[76:79], v23
    buffer_load_dwordx4 v[128:131], v6, s[12:15], s31 offen offset:0 nt
    s_waitcnt lgkmcnt(7)
    v_mfma_f32_32x32x16_bf16 a[64:79], v[80:83], v[200:203], a[64:79]
    v_mfma_f32_32x32x16_bf16 a[64:79], v[80:83], v[232:235], a[64:79]
    v_add_u32 v22, v25, v30
    ds_read_b128 v[80:83], v22
    s_waitcnt lgkmcnt(7)
    v_mfma_f32_32x32x16_bf16 a[64:79], v[84:87], v[204:207], a[64:79]
    v_mfma_f32_32x32x16_bf16 a[64:79], v[84:87], v[236:239], a[64:79]
    v_add_u32 v23, v25, v31
    ds_read_b128 v[84:87], v23
    buffer_load_dwordx4 v[132:135], v6, s[12:15], s31 offen offset:1024 nt
    s_waitcnt lgkmcnt(7)
    v_mfma_f32_32x32x16_bf16 a[64:79], v[88:91], v[208:211], a[64:79]
    v_mfma_f32_32x32x16_bf16 a[64:79], v[88:91], v[240:243], a[64:79]
    v_add_u32 v22, v25, v32
    ds_read_b128 v[88:91], v22
    s_waitcnt lgkmcnt(7)
    v_mfma_f32_32x32x16_bf16 a[64:79], v[92:95], v[212:215], a[64:79]
    v_mfma_f32_32x32x16_bf16 a[64:79], v[92:95], v[244:247], a[64:79]
    v_add_u32 v23, v25, v33
    ds_read_b128 v[92:95], v23
    buffer_load_dwordx4 v[136:139], v6, s[12:15], s31 offen offset:2048 nt
    s_waitcnt lgkmcnt(7)
    v_mfma_f32_32x32x16_bf16 a[64:79], v[96:99], v[216:219], a[64:79]
    v_mfma_f32_32x32x16_bf16 a[64:79], v[96:99], v[248:251], a[64:79]
    v_add_u32 v22, v25, v34
    ds_read_b128 v[96:99], v22
    s_waitcnt lgkmcnt(7)
    v_mfma_f32_32x32x16_bf16 a[64:79], v[100:103], v[220:223], a[64:79]
    v_mfma_f32_32x32x16_bf16 a[64:79], v[100:103], v[252:255], a[64:79]
    v_add_u32 v23, v25, v35
    ds_read_b128 v[100:103], v23
    buffer_load_dwordx4 v[140:143], v6, s[12:15], s31 offen offset:3072 nt
    s_waitcnt lgkmcnt(7)
    v_mfma_f32_32x32x16_bf16 a[80:95], v[72:75], v[192:195], 0
    v_mfma_f32_32x32x16_bf16 a[80:95], v[72:75], v[224:227], a[80:95]
    v_add_u32 v22, v26, v28
    ds_read_b128 v[72:75], v22
    s_waitcnt lgkmcnt(7)
    v_mfma_f32_32x32x16_bf16 a[80:95], v[76:79], v[196:199], a[80:95]
    v_mfma_f32_32x32x16_bf16 a[80:95], v[76:79], v[228:231], a[80:95]
    v_add_u32 v23, v26, v29
    ds_read_b128 v[76:79], v23
    buffer_load_dwordx4 v[144:147], v7, s[12:15], s31 offen offset:0 nt
    s_waitcnt lgkmcnt(7)
    v_mfma_f32_32x32x16_bf16 a[80:95], v[80:83], v[200:203], a[80:95]
    v_mfma_f32_32x32x16_bf16 a[80:95], v[80:83], v[232:235], a[80:95]
    v_add_u32 v22, v26, v30
    ds_read_b128 v[80:83], v22
    s_waitcnt lgkmcnt(7)
    v_mfma_f32_32x32x16_bf16 a[80:95], v[84:87], v[204:207], a[80:95]
    v_mfma_f32_32x32x16_bf16 a[80:95], v[84:87], v[236:239], a[80:95]
    v_add_u32 v23, v26, v31
    ds_read_b128 v[84:87], v23
    buffer_load_dwordx4 v[148:151], v7, s[12:15], s31 offen offset:1024 nt
    s_waitcnt lgkmcnt(7)
    v_mfma_f32_32x32x16_bf16 a[80:95], v[88:91], v[208:211], a[80:95]
    v_mfma_f32_32x32x16_bf16 a[80:95], v[88:91], v[240:243], a[80:95]
    v_add_u32 v22, v26, v32
    ds_read_b128 v[88:91], v22
    s_waitcnt lgkmcnt(7)
    v_mfma_f32_32x32x16_bf16 a[80:95], v[92:95], v[212:215], a[80:95]
    v_mfma_f32_32x32x16_bf16 a[80:95], v[92:95], v[244:247], a[80:95]
    v_add_u32 v23, v26, v33
    ds_read_b128 v[92:95], v23
    buffer_load_dwordx4 v[152:155], v7, s[12:15], s31 offen offset:2048 nt
    s_waitcnt lgkmcnt(7)
    v_mfma_f32_32x32x16_bf16 a[80:95], v[96:99], v[216:219], a[80:95]
    v_mfma_f32_32x32x16_bf16 a[80:95], v[96:99], v[248:251], a[80:95]
    v_add_u32 v22, v26, v34
    ds_read_b128 v[96:99], v22
    s_waitcnt lgkmcnt(7)
    v_mfma_f32_32x32x16_bf16 a[80:95], v[100:103], v[220:223], a[80:95]
    v_mfma_f32_32x32x16_bf16 a[80:95], v[100:103], v[252:255], a[80:95]
    v_add_u32 v23, v26, v35
    ds_read_b128 v[100:103], v23
    buffer_load_dwordx4 v[156:159], v7, s[12:15], s31 offen offset:3072 nt
    s_waitcnt lgkmcnt(7)
    v_mfma_f32_32x32x16_bf16 a[96:111], v[72:75], v[192:195], 0
    v_mfma_f32_32x32x16_bf16 a[96:111], v[72:75], v[224:227], a[96:111]
    v_add_u32 v22, v27, v28
    ds_read_b128 v[72:75], v22
    s_waitcnt lgkmcnt(7)
    v_mfma_f32_32x32x16_bf16 a[96:111], v[76:79], v[196:199], a[96:111]
    v_mfma_f32_32x32x16_bf16 a[96:111], v[76:79], v[228:231], a[96:111]
    v_add_u32 v23, v27, v29
    ds_read_b128 v[76:79], v23
    buffer_load_dwordx4 v[160:163], v6, s[16:19], s31 offen offset:0 nt
    s_waitcnt lgkmcnt(7)
    v_mfma_f32_32x32x16_bf16 a[96:111], v[80:83], v[200:203], a[96:111]
    v_mfma_f32_32x32x16_bf16 a[96:111], v[80:83], v[232:235], a[96:111]
    v_add_u32 v22, v27, v30
    ds_read_b128 v[80:83], v22
    s_waitcnt lgkmcnt(7)
    v_mfma_f32_32x32x16_bf16 a[96:111], v[84:87], v[204:207], a[96:111]
    v_mfma_f32_32x32x16_bf16 a[96:111], v[84:87], v[236:239], a[96:111]
    v_add_u32 v23, v27, v31
    ds_read_b128 v[84:87], v23
    buffer_load_dwordx4 v[164:167], v6, s[16:19], s31 offen offset:1024 nt
    s_waitcnt lgkmcnt(7)
    v_mfma_f32_32x32x16_bf16 a[96:111], v[88:91], v[208:211], a[96:111]
    v_mfma_f32_32x32x16_bf16 a[96:111], v[88:91], v[240:243], a[96:111]
    v_add_u32 v22, v27, v32
    ds_read_b128 v[88:91], v22
    s_waitcnt lgkmcnt(7)
    v_mfma_f32_32x32x16_bf16 a[96:111], v[92:95], v[212:215], a[96:111]
    v_mfma_f32_32x32x16_bf16 a[96:111], v[92:95], v[244:247], a[96:111]
    v_add_u32 v23, v27, v33
    ds_read_b128 v[92:95], v23
    buffer_load_dwordx4 v[168:171], v6, s[16:19], s31 offen offset:2048 nt
    s_waitcnt lgkmcnt(7)
    v_mfma_f32_32x32x16_bf16 a[96:111], v[96:99], v[216:219], a[96:111]
    v_mfma_f32_32x32x16_bf16 a[96:111], v[96:99], v[248:251], a[96:111]
    v_add_u32 v22, v27, v34
    ds_read_b128 v[96:99], v22
    s_waitcnt lgkmcnt(7)
    v_mfma_f32_32x32x16_bf16 a[96:111], v[100:103], v[220:223], a[96:111]
    v_mfma_f32_32x32x16_bf16 a[96:111], v[100:103], v[252:255], a[96:111]
    v_add_u32 v23, v27, v35
    ds_read_b128 v[100:103], v23
    buffer_load_dwordx4 v[172:175], v6, s[16:19], s31 offen offset:3072 nt
    s_waitcnt lgkmcnt(7)
    v_mfma_f32_32x32x16_bf16 a[112:127], v[72:75], v[192:195], 0
    v_mfma_f32_32x32x16_bf16 a[112:127], v[72:75], v[224:227], a[112:127]
    s_waitcnt lgkmcnt(6)
    v_mfma_f32_32x32x16_bf16 a[112:127], v[76:79], v[196:199], a[112:127]
    v_mfma_f32_32x32x16_bf16 a[112:127], v[76:79], v[228:231], a[112:127]
    buffer_load_dwordx4 v[176:179], v7, s[16:19], s31 offen offset:0 nt
    s_waitcnt lgkmcnt(5)
    v_mfma_f32_32x32x16_bf16 a[112:127], v[80:83], v[200:203], a[112:127]
    v_mfma_f32_32x32x16_bf16 a[112:127], v[80:83], v[232:235], a[112:127]
    s_waitcnt lgkmcnt(4)
    v_mfma_f32_32x32x16_bf16 a[112:127], v[84:87], v[204:207], a[112:127]
    v_mfma_f32_32x32x16_bf16 a[112:127], v[84:87], v[236:239], a[112:127]
    buffer_load_dwordx4 v[180:183], v7, s[16:19], s31 offen offset:1024 nt
    s_waitcnt lgkmcnt(3)
    v_mfma_f32_32x32x16_bf16 a[112:127], v[88:91], v[208:211], a[112:127]
    v_mfma_f32_32x32x16_bf16 a[112:127], v[88:91], v[240:243], a[112:127]
    s_waitcnt lgkmcnt(2)
    v_mfma_f32_32x32x16_bf16 a[112:127], v[92:95], v[212:215], a[112:127]
    v_mfma_f32_32x32x16_bf16 a[112:127], v[92:95], v[244:247], a[112:127]
    buffer_load_dwordx4 v[184:187], v7, s[16:19], s31 offen offset:2048 nt
    s_waitcnt lgkmcnt(1)
    v_mfma_f32_32x32x16_bf16 a[112:127], v[96:99], v[216:219], a[112:127]
    v_mfma_f32_32x32x16_bf16 a[112:127], v[96:99], v[248:251], a[112:127]
    s_waitcnt lgkmcnt(0)
    v_mfma_f32_32x32x16_bf16 a[112:127], v[100:103], v[220:223], a[112:127]
    v_mfma_f32_32x32x16_bf16 a[112:127], v[100:103], v[252:255], a[112:127]
    buffer_load_dwordx4 v[188:191], v7, s[16:19], s31 offen offset:3072 nt
    s_nop 15
    v_accvgpr_read_b32 v56, a64
    v_accvgpr_read_b32 v57, a65
    v_accvgpr_read_b32 v58, a66
    v_accvgpr_read_b32 v59, a67
    v_accvgpr_read_b32 v60, a68
    v_accvgpr_read_b32 v61, a69
    v_accvgpr_read_b32 v62, a70
    v_accvgpr_read_b32 v63, a71
    v_accvgpr_read_b32 v64, a72
    v_accvgpr_read_b32 v65, a73
    v_accvgpr_read_b32 v66, a74
    v_accvgpr_read_b32 v67, a75
    v_accvgpr_read_b32 v68, a76
    v_accvgpr_read_b32 v69, a77
    v_accvgpr_read_b32 v70, a78
    v_accvgpr_read_b32 v71, a79
    ds_write_b128 v36, a[80:83] offset:0
    ds_write_b128 v36, a[84:87] offset:1024
    ds_write_b128 v36, a[88:91] offset:2048
    ds_write_b128 v36, a[92:95] offset:3072
    s_waitcnt lgkmcnt(0)
    s_barrier
    ds_read_b128 v[72:75], v37 offset:0
    ds_read_b128 v[76:79], v37 offset:1024
    ds_read_b128 v[80:83], v37 offset:2048
    ds_read_b128 v[84:87], v37 offset:3072
    s_waitcnt lgkmcnt(0)
    s_barrier
    buffer_load_dwordx4 a[128:131], v6, s[12:15], s33 offen offset:0 nt
    v_add_f32 v56, v56, v72
    v_add_f32 v57, v57, v73
    v_add_f32 v58, v58, v74
    v_add_f32 v59, v59, v75
    v_add_f32 v60, v60, v76
    v_add_f32 v61, v61, v77
    v_add_f32 v62, v62, v78
    v_add_f32 v63, v63, v79
    v_add_f32 v64, v64, v80
    v_add_f32 v65, v65, v81
    v_add_f32 v66, v66, v82
    v_add_f32 v67, v67, v83
    v_add_f32 v68, v68, v84
    v_add_f32 v69, v69, v85
    v_add_f32 v70, v70, v86
    v_add_f32 v71, v71, v87
    ds_write_b128 v36, a[96:99] offset:0
    ds_write_b128 v36, a[100:103] offset:1024
    ds_write_b128 v36, a[104:107] offset:2048
    ds_write_b128 v36, a[108:111] offset:3072
    s_waitcnt lgkmcnt(0)
    s_barrier
    ds_read_b128 v[72:75], v38 offset:0
    ds_read_b128 v[76:79], v38 offset:1024
    ds_read_b128 v[80:83], v38 offset:2048
    ds_read_b128 v[84:87], v38 offset:3072
    s_waitcnt lgkmcnt(0)
    s_barrier
    buffer_load_dwordx4 a[132:135], v6, s[12:15], s33 offen offset:1024 nt
    v_add_f32 v56, v56, v72
    v_add_f32 v57, v57, v73
    v_add_f32 v58, v58, v74
    v_add_f32 v59, v59, v75
    v_add_f32 v60, v60, v76
    v_add_f32 v61, v61, v77
    v_add_f32 v62, v62, v78
    v_add_f32 v63, v63, v79
    v_add_f32 v64, v64, v80
    v_add_f32 v65, v65, v81
    v_add_f32 v66, v66, v82
    v_add_f32 v67, v67, v83
    v_add_f32 v68, v68, v84
    v_add_f32 v69, v69, v85
    v_add_f32 v70, v70, v86
    v_add_f32 v71, v71, v87
    ds_write_b128 v36, a[112:115] offset:0
    ds_write_b128 v36, a[116:119] offset:1024
    ds_write_b128 v36, a[120:123] offset:2048
    ds_write_b128 v36, a[124:127] offset:3072
    s_waitcnt lgkmcnt(0)
    s_barrier
    ds_read_b128 v[72:75], v39 offset:0
    ds_read_b128 v[76:79], v39 offset:1024
    ds_read_b128 v[80:83], v39 offset:2048
    ds_read_b128 v[84:87], v39 offset:3072
    s_waitcnt lgkmcnt(0)
    buffer_load_dwordx4 a[136:139], v6, s[12:15], s33 offen offset:2048 nt
    v_add_f32 v56, v56, v72
    v_add_f32 v57, v57, v73
    v_add_f32 v58, v58, v74
    v_add_f32 v59, v59, v75
    v_add_f32 v60, v60, v76
    v_add_f32 v61, v61, v77
    v_add_f32 v62, v62, v78
    v_add_f32 v63, v63, v79
    v_add_f32 v64, v64, v80
    v_add_f32 v65, v65, v81
    v_add_f32 v66, v66, v82
    v_add_f32 v67, v67, v83
    v_add_f32 v68, v68, v84
    v_add_f32 v69, v69, v85
    v_add_f32 v70, v70, v86
    v_add_f32 v71, v71, v87
    v_cvt_pk_bf16_f32 v11, v56, v57
    v_lshlrev_b32 v56, 16, v11
    v_and_b32 v57, 0xffff0000, v11
    v_mul_f32 v56, s34, v56
    v_mul_f32 v57, s34, v57
    v_cvt_pk_bf16_f32 v11, v56, v57
    v_lshlrev_b32 v56, 16, v11
    v_and_b32 v57, 0xffff0000, v11
    v_mul_f32 v56, s35, v56
    v_mul_f32 v57, s35, v57
    buffer_load_dwordx4 a[140:143], v6, s[12:15], s33 offen offset:3072 nt
    v_cvt_pk_bf16_f32 v11, v58, v59
    v_lshlrev_b32 v58, 16, v11
    v_and_b32 v59, 0xffff0000, v11
    v_mul_f32 v58, s34, v58
    v_mul_f32 v59, s34, v59
    v_cvt_pk_bf16_f32 v11, v58, v59
    v_lshlrev_b32 v58, 16, v11
    v_and_b32 v59, 0xffff0000, v11
    v_mul_f32 v58, s35, v58
    v_mul_f32 v59, s35, v59
    v_cvt_pk_bf16_f32 v11, v60, v61
    v_lshlrev_b32 v60, 16, v11
    v_and_b32 v61, 0xffff0000, v11
    v_mul_f32 v60, s34, v60
    v_mul_f32 v61, s34, v61
    v_cvt_pk_bf16_f32 v11, v60, v61
    v_lshlrev_b32 v60, 16, v11
    v_and_b32 v61, 0xffff0000, v11
    v_mul_f32 v60, s35, v60
    v_mul_f32 v61, s35, v61
    buffer_load_dwordx4 a[144:147], v7, s[12:15], s33 offen offset:0 nt
    v_cvt_pk_bf16_f32 v11, v62, v63
    v_lshlrev_b32 v62, 16, v11
    v_and_b32 v63, 0xffff0000, v11
    v_mul_f32 v62, s34, v62
    v_mul_f32 v63, s34, v63
    v_cvt_pk_bf16_f32 v11, v62, v63
    v_lshlrev_b32 v62, 16, v11
    v_and_b32 v63, 0xffff0000, v11
    v_mul_f32 v62, s35, v62
    v_mul_f32 v63, s35, v63
    v_cvt_pk_bf16_f32 v11, v64, v65
    v_lshlrev_b32 v64, 16, v11
    v_and_b32 v65, 0xffff0000, v11
    v_mul_f32 v64, s34, v64
    v_mul_f32 v65, s34, v65
    v_cvt_pk_bf16_f32 v11, v64, v65
    v_lshlrev_b32 v64, 16, v11
    v_and_b32 v65, 0xffff0000, v11
    v_mul_f32 v64, s35, v64
    v_mul_f32 v65, s35, v65
    buffer_load_dwordx4 a[148:151], v7, s[12:15], s33 offen offset:1024 nt
    v_cvt_pk_bf16_f32 v11, v66, v67
    v_lshlrev_b32 v66, 16, v11
    v_and_b32 v67, 0xffff0000, v11
    v_mul_f32 v66, s34, v66
    v_mul_f32 v67, s34, v67
    v_cvt_pk_bf16_f32 v11, v66, v67
    v_lshlrev_b32 v66, 16, v11
    v_and_b32 v67, 0xffff0000, v11
    v_mul_f32 v66, s35, v66
    v_mul_f32 v67, s35, v67
    v_cvt_pk_bf16_f32 v11, v68, v69
    v_lshlrev_b32 v68, 16, v11
    v_and_b32 v69, 0xffff0000, v11
    v_mul_f32 v68, s34, v68
    v_mul_f32 v69, s34, v69
    v_cvt_pk_bf16_f32 v11, v68, v69
    v_lshlrev_b32 v68, 16, v11
    v_and_b32 v69, 0xffff0000, v11
    v_mul_f32 v68, s35, v68
    v_mul_f32 v69, s35, v69
    buffer_load_dwordx4 a[152:155], v7, s[12:15], s33 offen offset:2048 nt
    v_cvt_pk_bf16_f32 v11, v70, v71
    v_lshlrev_b32 v70, 16, v11
    v_and_b32 v71, 0xffff0000, v11
    v_mul_f32 v70, s34, v70
    v_mul_f32 v71, s34, v71
    v_cvt_pk_bf16_f32 v11, v70, v71
    v_lshlrev_b32 v70, 16, v11
    v_and_b32 v71, 0xffff0000, v11
    v_mul_f32 v70, s35, v70
    v_mul_f32 v71, s35, v71
    v_max3_f32 v12, v56, v57, v58
    v_max3_f32 v12, v12, v59, v60
    v_max3_f32 v12, v12, v61, v62
    v_max3_f32 v12, v12, v63, v64
    v_max3_f32 v12, v12, v65, v66
    v_max3_f32 v12, v12, v67, v68
    v_max3_f32 v12, v12, v69, v70
    v_max_f32 v12, v12, v71
    v_mov_b32 v13, v12
    s_nop 1
    v_permlane32_swap_b32 v12, v13
    s_nop 1
    v_max_f32 v12, v12, v13
    ds_write_b32 v17, v12
    s_waitcnt lgkmcnt(0)
    s_barrier
    ds_read_b32 v12, v18 offset:0
    ds_read_b32 v13, v18 offset:128
    ds_read_b32 v14, v18 offset:256
    ds_read_b32 v15, v18 offset:384
    s_waitcnt lgkmcnt(0)
    v_max3_f32 v12, v12, v13, v14
    v_max3_f32 v12, v12, v15, v8
    v_sub_f32 v10, v8, v12
    v_exp_f32 v10, v10
    v_mov_b32 v8, v12
    v_sub_f32 v56, v56, v12
    v_sub_f32 v57, v57, v12
    v_sub_f32 v58, v58, v12
    v_sub_f32 v59, v59, v12
    v_sub_f32 v60, v60, v12
    v_sub_f32 v61, v61, v12
    v_sub_f32 v62, v62, v12
    v_sub_f32 v63, v63, v12
    v_sub_f32 v64, v64, v12
    v_sub_f32 v65, v65, v12
    v_sub_f32 v66, v66, v12
    v_sub_f32 v67, v67, v12
    v_sub_f32 v68, v68, v12
    v_sub_f32 v69, v69, v12
    v_sub_f32 v70, v70, v12
    v_sub_f32 v71, v71, v12
    v_exp_f32 v56, v56
    v_exp_f32 v57, v57
    v_exp_f32 v58, v58
    v_exp_f32 v59, v59
    v_exp_f32 v60, v60
    v_exp_f32 v61, v61
    v_exp_f32 v62, v62
    v_exp_f32 v63, v63
    v_exp_f32 v64, v64
    v_exp_f32 v65, v65
    v_exp_f32 v66, v66
    v_exp_f32 v67, v67
    v_exp_f32 v68, v68
    v_exp_f32 v69, v69
    v_exp_f32 v70, v70
    v_exp_f32 v71, v71
    v_mul_f32 v9, v9, v10
    v_add_f32 v9, v9, v56
    v_add_f32 v9, v9, v57
    v_add_f32 v9, v9, v58
    v_add_f32 v9, v9, v59
    v_add_f32 v9, v9, v60
    v_add_f32 v9, v9, v61
    v_add_f32 v9, v9, v62
    v_add_f32 v9, v9, v63
    v_add_f32 v9, v9, v64
    v_add_f32 v9, v9, v65
    v_add_f32 v9, v9, v66
    v_add_f32 v9, v9, v67
    v_add_f32 v9, v9, v68
    v_add_f32 v9, v9, v69
    v_add_f32 v9, v9, v70
    v_add_f32 v9, v9, v71
    v_cvt_pk_bf16_f32 v96, v56, v57
    v_cvt_pk_bf16_f32 v97, v58, v59
    v_cvt_pk_bf16_f32 v98, v60, v61
    v_cvt_pk_bf16_f32 v99, v62, v63
    v_cvt_pk_bf16_f32 v100, v64, v65
    v_cvt_pk_bf16_f32 v101, v66, v67
    v_cvt_pk_bf16_f32 v102, v68, v69
    v_cvt_pk_bf16_f32 v103, v70, v71
    ds_write_b128 v19, v[96:99]
    ds_write_b128 v19, v[100:103] offset:1024
    s_waitcnt lgkmcnt(0)
    s_barrier
    ds_read_b128 v[64:67], v20 offset:0
    ds_read_b128 v[68:71], v20 offset:1024
    ds_read_b128 v[72:75], v20 offset:2048
    ds_read_b128 v[76:79], v20 offset:3072
    ds_read_b128 v[80:83], v20 offset:4096
    ds_read_b128 v[84:87], v20 offset:5120
    ds_read_b128 v[88:91], v20 offset:6144
    ds_read_b128 v[92:95], v20 offset:7168
    ds_read_b64_tr_b16 v[96:97], v40 offset:0
    ds_read_b64_tr_b16 v[98:99], v41 offset:8192
    ds_read_b64_tr_b16 v[100:101], v42 offset:0
    ds_read_b64_tr_b16 v[102:103], v43 offset:8192
    ds_read_b64_tr_b16 v[104:105], v44 offset:0
    ds_read_b64_tr_b16 v[106:107], v45 offset:8192
    ds_read_b64_tr_b16 v[108:109], v46 offset:0
    ds_read_b64_tr_b16 v[110:111], v47 offset:8192
    ds_read_b64_tr_b16 v[112:113], v40 offset:16384
    ds_read_b64_tr_b16 v[114:115], v41 offset:24576
    ds_read_b64_tr_b16 v[116:117], v42 offset:16384
    ds_read_b64_tr_b16 v[118:119], v43 offset:24576
    ds_read_b64_tr_b16 v[120:121], v44 offset:16384
    ds_read_b64_tr_b16 v[122:123], v45 offset:24576
    ds_read_b64_tr_b16 v[124:125], v46 offset:16384
    ds_read_b64_tr_b16 v[126:127], v47 offset:24576
    s_waitcnt lgkmcnt(8)
    v_mfma_f32_32x32x16_bf16 v[192:207], v[96:99], v[64:67], 0
    v_mfma_f32_32x32x16_bf16 v[208:223], v[100:103], v[64:67], 0
    v_mfma_f32_32x32x16_bf16 v[224:239], v[104:107], v[64:67], 0
    v_mfma_f32_32x32x16_bf16 v[240:255], v[108:111], v[64:67], 0
    buffer_load_dwordx4 a[156:159], v7, s[12:15], s33 offen offset:3072 nt
    ds_read_b64_tr_b16 v[96:97], v40 offset:32768
    ds_read_b64_tr_b16 v[98:99], v41 offset:40960
    ds_read_b64_tr_b16 v[100:101], v42 offset:32768
    ds_read_b64_tr_b16 v[102:103], v43 offset:40960
    ds_read_b64_tr_b16 v[104:105], v44 offset:32768
    ds_read_b64_tr_b16 v[106:107], v45 offset:40960
    ds_read_b64_tr_b16 v[108:109], v46 offset:32768
    ds_read_b64_tr_b16 v[110:111], v47 offset:40960
    s_waitcnt lgkmcnt(8)
    v_mfma_f32_32x32x16_bf16 v[192:207], v[112:115], v[68:71], v[192:207]
    v_mfma_f32_32x32x16_bf16 v[208:223], v[116:119], v[68:71], v[208:223]
    v_mfma_f32_32x32x16_bf16 v[224:239], v[120:123], v[68:71], v[224:239]
    v_mfma_f32_32x32x16_bf16 v[240:255], v[124:127], v[68:71], v[240:255]
    buffer_load_dwordx4 a[160:163], v6, s[16:19], s33 offen offset:0 nt
    ds_read_b64_tr_b16 v[112:113], v40 offset:49152
    ds_read_b64_tr_b16 v[114:115], v41 offset:57344
    ds_read_b64_tr_b16 v[116:117], v42 offset:49152
    ds_read_b64_tr_b16 v[118:119], v43 offset:57344
    ds_read_b64_tr_b16 v[120:121], v44 offset:49152
    ds_read_b64_tr_b16 v[122:123], v45 offset:57344
    ds_read_b64_tr_b16 v[124:125], v46 offset:49152
    ds_read_b64_tr_b16 v[126:127], v47 offset:57344
    s_waitcnt lgkmcnt(8)
    v_mfma_f32_32x32x16_bf16 v[192:207], v[96:99], v[72:75], v[192:207]
    v_mfma_f32_32x32x16_bf16 v[208:223], v[100:103], v[72:75], v[208:223]
    v_mfma_f32_32x32x16_bf16 v[224:239], v[104:107], v[72:75], v[224:239]
    v_mfma_f32_32x32x16_bf16 v[240:255], v[108:111], v[72:75], v[240:255]
    buffer_load_dwordx4 a[164:167], v6, s[16:19], s33 offen offset:1024 nt
    ds_read_b64_tr_b16 v[96:97], v48 offset:0
    ds_read_b64_tr_b16 v[98:99], v49 offset:8192
    ds_read_b64_tr_b16 v[100:101], v50 offset:0
    ds_read_b64_tr_b16 v[102:103], v51 offset:8192
    ds_read_b64_tr_b16 v[104:105], v52 offset:0
    ds_read_b64_tr_b16 v[106:107], v53 offset:8192
    ds_read_b64_tr_b16 v[108:109], v54 offset:0
    ds_read_b64_tr_b16 v[110:111], v55 offset:8192
    s_waitcnt lgkmcnt(8)
    v_mfma_f32_32x32x16_bf16 v[192:207], v[112:115], v[76:79], v[192:207]
    v_mfma_f32_32x32x16_bf16 v[208:223], v[116:119], v[76:79], v[208:223]
    v_mfma_f32_32x32x16_bf16 v[224:239], v[120:123], v[76:79], v[224:239]
    v_mfma_f32_32x32x16_bf16 v[240:255], v[124:127], v[76:79], v[240:255]
    buffer_load_dwordx4 a[168:171], v6, s[16:19], s33 offen offset:2048 nt
    ds_read_b64_tr_b16 v[112:113], v48 offset:16384
    ds_read_b64_tr_b16 v[114:115], v49 offset:24576
    ds_read_b64_tr_b16 v[116:117], v50 offset:16384
    ds_read_b64_tr_b16 v[118:119], v51 offset:24576
    ds_read_b64_tr_b16 v[120:121], v52 offset:16384
    ds_read_b64_tr_b16 v[122:123], v53 offset:24576
    ds_read_b64_tr_b16 v[124:125], v54 offset:16384
    ds_read_b64_tr_b16 v[126:127], v55 offset:24576
    s_waitcnt lgkmcnt(8)
    v_mfma_f32_32x32x16_bf16 v[192:207], v[96:99], v[80:83], v[192:207]
    v_mfma_f32_32x32x16_bf16 v[208:223], v[100:103], v[80:83], v[208:223]
    v_mfma_f32_32x32x16_bf16 v[224:239], v[104:107], v[80:83], v[224:239]
    v_mfma_f32_32x32x16_bf16 v[240:255], v[108:111], v[80:83], v[240:255]
    buffer_load_dwordx4 a[172:175], v6, s[16:19], s33 offen offset:3072 nt
    ds_read_b64_tr_b16 v[96:97], v48 offset:32768
    ds_read_b64_tr_b16 v[98:99], v49 offset:40960
    ds_read_b64_tr_b16 v[100:101], v50 offset:32768
    ds_read_b64_tr_b16 v[102:103], v51 offset:40960
    ds_read_b64_tr_b16 v[104:105], v52 offset:32768
    ds_read_b64_tr_b16 v[106:107], v53 offset:40960
    ds_read_b64_tr_b16 v[108:109], v54 offset:32768
    ds_read_b64_tr_b16 v[110:111], v55 offset:40960
    s_waitcnt lgkmcnt(8)
    v_mfma_f32_32x32x16_bf16 v[192:207], v[112:115], v[84:87], v[192:207]
    v_mfma_f32_32x32x16_bf16 v[208:223], v[116:119], v[84:87], v[208:223]
    v_mfma_f32_32x32x16_bf16 v[224:239], v[120:123], v[84:87], v[224:239]
    v_mfma_f32_32x32x16_bf16 v[240:255], v[124:127], v[84:87], v[240:255]
    buffer_load_dwordx4 a[176:179], v7, s[16:19], s33 offen offset:0 nt
    ds_read_b64_tr_b16 v[112:113], v48 offset:49152
    ds_read_b64_tr_b16 v[114:115], v49 offset:57344
    ds_read_b64_tr_b16 v[116:117], v50 offset:49152
    ds_read_b64_tr_b16 v[118:119], v51 offset:57344
    ds_read_b64_tr_b16 v[120:121], v52 offset:49152
    ds_read_b64_tr_b16 v[122:123], v53 offset:57344
    ds_read_b64_tr_b16 v[124:125], v54 offset:49152
    ds_read_b64_tr_b16 v[126:127], v55 offset:57344
    s_waitcnt lgkmcnt(8)
    v_mfma_f32_32x32x16_bf16 v[192:207], v[96:99], v[88:91], v[192:207]
    v_mfma_f32_32x32x16_bf16 v[208:223], v[100:103], v[88:91], v[208:223]
    v_mfma_f32_32x32x16_bf16 v[224:239], v[104:107], v[88:91], v[224:239]
    v_mfma_f32_32x32x16_bf16 v[240:255], v[108:111], v[88:91], v[240:255]
    buffer_load_dwordx4 a[180:183], v7, s[16:19], s33 offen offset:1024 nt
    s_waitcnt lgkmcnt(0)
    v_mfma_f32_32x32x16_bf16 v[192:207], v[112:115], v[92:95], v[192:207]
    v_mfma_f32_32x32x16_bf16 v[208:223], v[116:119], v[92:95], v[208:223]
    v_mfma_f32_32x32x16_bf16 v[224:239], v[120:123], v[92:95], v[224:239]
    v_mfma_f32_32x32x16_bf16 v[240:255], v[124:127], v[92:95], v[240:255]
    buffer_load_dwordx4 a[184:187], v7, s[16:19], s33 offen offset:2048 nt
    buffer_load_dwordx4 a[188:191], v7, s[16:19], s33 offen offset:3072 nt
    v_mov_b32 v13, v9
    s_nop 1
    v_permlane32_swap_b32 v9, v13
    s_nop 1
    v_add_f32 v9, v9, v13
    ds_write_b32 v17, v9 offset:512
    s_nop 7
    s_barrier
    v_and_b32 v11, 31, v1
    v_lshrrev_b32 v12, 5, v1
    s_movk_i32 s27, 1040
    v_mul_lo_u32 v14, v11, s27
    v_lshl_add_u32 v14, v12, 3, v14
    s_lshl_b32 s28, s26, 8
    v_add_u32 v14, s28, v14
    v_cvt_pk_bf16_f32 v192, v192, v193
    v_cvt_pk_bf16_f32 v193, v194, v195
    ds_write_b64 v14, v[192:193] offset:0
    v_cvt_pk_bf16_f32 v196, v196, v197
    v_cvt_pk_bf16_f32 v197, v198, v199
    ds_write_b64 v14, v[196:197] offset:16
    v_cvt_pk_bf16_f32 v200, v200, v201
    v_cvt_pk_bf16_f32 v201, v202, v203
    ds_write_b64 v14, v[200:201] offset:32
    v_cvt_pk_bf16_f32 v204, v204, v205
    v_cvt_pk_bf16_f32 v205, v206, v207
    ds_write_b64 v14, v[204:205] offset:48
    v_cvt_pk_bf16_f32 v208, v208, v209
    v_cvt_pk_bf16_f32 v209, v210, v211
    ds_write_b64 v14, v[208:209] offset:64
    v_cvt_pk_bf16_f32 v212, v212, v213
    v_cvt_pk_bf16_f32 v213, v214, v215
    ds_write_b64 v14, v[212:213] offset:80
    v_cvt_pk_bf16_f32 v216, v216, v217
    v_cvt_pk_bf16_f32 v217, v218, v219
    ds_write_b64 v14, v[216:217] offset:96
    v_cvt_pk_bf16_f32 v220, v220, v221
    v_cvt_pk_bf16_f32 v221, v222, v223
    ds_write_b64 v14, v[220:221] offset:112
    v_cvt_pk_bf16_f32 v224, v224, v225
    v_cvt_pk_bf16_f32 v225, v226, v227
    ds_write_b64 v14, v[224:225] offset:128
    v_cvt_pk_bf16_f32 v228, v228, v229
    v_cvt_pk_bf16_f32 v229, v230, v231
    ds_write_b64 v14, v[228:229] offset:144
    v_cvt_pk_bf16_f32 v232, v232, v233
    v_cvt_pk_bf16_f32 v233, v234, v235
    ds_write_b64 v14, v[232:233] offset:160
    v_cvt_pk_bf16_f32 v236, v236, v237
    v_cvt_pk_bf16_f32 v237, v238, v239
    ds_write_b64 v14, v[236:237] offset:176
    v_cvt_pk_bf16_f32 v240, v240, v241
    v_cvt_pk_bf16_f32 v241, v242, v243
    ds_write_b64 v14, v[240:241] offset:192
    v_cvt_pk_bf16_f32 v244, v244, v245
    v_cvt_pk_bf16_f32 v245, v246, v247
    ds_write_b64 v14, v[244:245] offset:208
    v_cvt_pk_bf16_f32 v248, v248, v249
    v_cvt_pk_bf16_f32 v249, v250, v251
    ds_write_b64 v14, v[248:249] offset:224
    v_cvt_pk_bf16_f32 v252, v252, v253
    v_cvt_pk_bf16_f32 v253, v254, v255
    ds_write_b64 v14, v[252:253] offset:240
    s_waitcnt lgkmcnt(0)
    s_barrier
    s_mul_i32 s28, s26, 8320
    v_add_u32 v14, s28, v16
    ds_read_b128 v[192:195], v14 offset:0
    ds_read_b128 v[196:199], v14 offset:1040
    ds_read_b128 v[200:203], v14 offset:2080
    ds_read_b128 v[204:207], v14 offset:3120
    ds_read_b128 v[208:211], v14 offset:4160
    ds_read_b128 v[212:215], v14 offset:5200
    ds_read_b128 v[216:219], v14 offset:6240
    ds_read_b128 v[220:223], v14 offset:7280
    s_lshl_b32 s27, s36, 6
    s_add_u32 s27, s27, s37
    s_lshl_b32 s27, s27, 15
    s_lshl_b32 s28, s26, 13
    s_add_u32 s27, s27, s28
    s_add_u32 s27, s27, 1048576
    s_waitcnt lgkmcnt(7)
    buffer_store_dwordx4 v[192:195], v16, s[20:23], s27 offen offset:0
    s_waitcnt lgkmcnt(6)
    buffer_store_dwordx4 v[196:199], v16, s[20:23], s27 offen offset:1024
    s_waitcnt lgkmcnt(5)
    buffer_store_dwordx4 v[200:203], v16, s[20:23], s27 offen offset:2048
    s_waitcnt lgkmcnt(4)
    buffer_store_dwordx4 v[204:207], v16, s[20:23], s27 offen offset:3072
    s_add_u32 s27, s27, 4096
    s_waitcnt lgkmcnt(3)
    buffer_store_dwordx4 v[208:211], v16, s[20:23], s27 offen offset:0
    s_waitcnt lgkmcnt(2)
    buffer_store_dwordx4 v[212:215], v16, s[20:23], s27 offen offset:1024
    s_waitcnt lgkmcnt(1)
    buffer_store_dwordx4 v[216:219], v16, s[20:23], s27 offen offset:2048
    s_waitcnt lgkmcnt(0)
    buffer_store_dwordx4 v[220:223], v16, s[20:23], s27 offen offset:3072
    s_cmp_lg_u32 s26, 0
    s_cbranch_scc1 KM_ASTAT_DONE
    ds_read_b32 v12, v18 offset:512
    ds_read_b32 v13, v18 offset:640
    ds_read_b32 v14, v18 offset:768
    ds_read_b32 v15, v18 offset:896
    s_waitcnt lgkmcnt(0)
    v_add_f32 v12, v12, v13
    v_add_f32 v14, v14, v15
    v_add_f32 v9, v12, v14
    v_lshlrev_b32 v14, 9, v11
    s_lshl_b32 s27, s36, 14
    s_lshl_b32 s28, s37, 3
    s_add_u32 s27, s27, s28
    s_add_u32 s27, s27, 196608
    buffer_store_dwordx2 v[8:9], v14, s[20:23], s27 offen
KM_ASTAT_DONE:
    v_mov_b32 v8, 0xff800000
    v_mov_b32 v9, 0
    v_mov_b32 v10, 0
    v_mov_b32 v11, 0
    v_mov_b32 v12, 0
    v_mov_b32 v13, 0
    v_mov_b32 v14, 0
    v_mov_b32 v15, 0
    v_mov_b32 v16, 0
    v_mov_b32 v17, 0
    s_waitcnt vmcnt(0)
    v_dot2_f32_bf16 v18, v128, v2, 0
    v_dot2_f32_bf16 v19, v132, v2, 0
    v_dot2_f32_bf16 v20, v136, v2, 0
    v_dot2_f32_bf16 v21, v140, v2, 0
    v_dot2_f32_bf16 v22, v144, v2, 0
    v_dot2_f32_bf16 v23, v148, v2, 0
    v_dot2_f32_bf16 v24, v152, v2, 0
    v_dot2_f32_bf16 v25, v156, v2, 0
    v_dot2_f32_bf16 v18, v129, v3, v18
    v_dot2_f32_bf16 v19, v133, v3, v19
    v_dot2_f32_bf16 v20, v137, v3, v20
    v_dot2_f32_bf16 v21, v141, v3, v21
    v_dot2_f32_bf16 v22, v145, v3, v22
    v_dot2_f32_bf16 v23, v149, v3, v23
    v_dot2_f32_bf16 v24, v153, v3, v24
    v_dot2_f32_bf16 v25, v157, v3, v25
    v_dot2_f32_bf16 v18, v130, v4, v18
    v_dot2_f32_bf16 v19, v134, v4, v19
    v_dot2_f32_bf16 v20, v138, v4, v20
    v_dot2_f32_bf16 v21, v142, v4, v21
    v_dot2_f32_bf16 v22, v146, v4, v22
    v_dot2_f32_bf16 v23, v150, v4, v23
    v_dot2_f32_bf16 v24, v154, v4, v24
    v_dot2_f32_bf16 v25, v158, v4, v25
    v_dot2_f32_bf16 v18, v131, v5, v18
    v_dot2_f32_bf16 v19, v135, v5, v19
    v_dot2_f32_bf16 v20, v139, v5, v20
    v_dot2_f32_bf16 v21, v143, v5, v21
    v_dot2_f32_bf16 v22, v147, v5, v22
    v_dot2_f32_bf16 v23, v151, v5, v23
    v_dot2_f32_bf16 v24, v155, v5, v24
    v_dot2_f32_bf16 v25, v159, v5, v25
    v_add_f32_dpp v18, v18, v18 row_ror:8 row_mask:0xf bank_mask:0xf
    v_add_f32_dpp v19, v19, v19 row_ror:8 row_mask:0xf bank_mask:0xf
    v_add_f32_dpp v20, v20, v20 row_ror:8 row_mask:0xf bank_mask:0xf
    v_add_f32_dpp v21, v21, v21 row_ror:8 row_mask:0xf bank_mask:0xf
    v_add_f32_dpp v22, v22, v22 row_ror:8 row_mask:0xf bank_mask:0xf
    v_add_f32_dpp v23, v23, v23 row_ror:8 row_mask:0xf bank_mask:0xf
    v_add_f32_dpp v24, v24, v24 row_ror:8 row_mask:0xf bank_mask:0xf
    v_add_f32_dpp v25, v25, v25 row_ror:8 row_mask:0xf bank_mask:0xf
    v_add_f32_dpp v18, v18, v18 row_ror:4 row_mask:0xf bank_mask:0xf
    v_add_f32_dpp v19, v19, v19 row_ror:4 row_mask:0xf bank_mask:0xf
    v_add_f32_dpp v20, v20, v20 row_ror:4 row_mask:0xf bank_mask:0xf
    v_add_f32_dpp v21, v21, v21 row_ror:4 row_mask:0xf bank_mask:0xf
    v_add_f32_dpp v22, v22, v22 row_ror:4 row_mask:0xf bank_mask:0xf
    v_add_f32_dpp v23, v23, v23 row_ror:4 row_mask:0xf bank_mask:0xf
    v_add_f32_dpp v24, v24, v24 row_ror:4 row_mask:0xf bank_mask:0xf
    v_add_f32_dpp v25, v25, v25 row_ror:4 row_mask:0xf bank_mask:0xf
    v_add_f32_dpp v18, v18, v18 row_ror:2 row_mask:0xf bank_mask:0xf
    v_add_f32_dpp v19, v19, v19 row_ror:2 row_mask:0xf bank_mask:0xf
    v_add_f32_dpp v20, v20, v20 row_ror:2 row_mask:0xf bank_mask:0xf
    v_add_f32_dpp v21, v21, v21 row_ror:2 row_mask:0xf bank_mask:0xf
    v_add_f32_dpp v22, v22, v22 row_ror:2 row_mask:0xf bank_mask:0xf
    v_add_f32_dpp v23, v23, v23 row_ror:2 row_mask:0xf bank_mask:0xf
    v_add_f32_dpp v24, v24, v24 row_ror:2 row_mask:0xf bank_mask:0xf
    v_add_f32_dpp v25, v25, v25 row_ror:2 row_mask:0xf bank_mask:0xf
    v_add_f32_dpp v18, v18, v18 row_ror:1 row_mask:0xf bank_mask:0xf
    v_add_f32_dpp v19, v19, v19 row_ror:1 row_mask:0xf bank_mask:0xf
    v_add_f32_dpp v20, v20, v20 row_ror:1 row_mask:0xf bank_mask:0xf
    v_add_f32_dpp v21, v21, v21 row_ror:1 row_mask:0xf bank_mask:0xf
    v_add_f32_dpp v22, v22, v22 row_ror:1 row_mask:0xf bank_mask:0xf
    v_add_f32_dpp v23, v23, v23 row_ror:1 row_mask:0xf bank_mask:0xf
    v_add_f32_dpp v24, v24, v24 row_ror:1 row_mask:0xf bank_mask:0xf
    v_add_f32_dpp v25, v25, v25 row_ror:1 row_mask:0xf bank_mask:0xf
    v_cvt_pk_bf16_f32 v26, v18, v19
    v_lshlrev_b32 v18, 16, v26
    v_and_b32 v19, 0xffff0000, v26
    v_mul_f32 v18, s34, v18
    v_mul_f32 v19, s34, v19
    v_cvt_pk_bf16_f32 v26, v18, v19
    v_lshlrev_b32 v18, 16, v26
    v_and_b32 v19, 0xffff0000, v26
    v_mul_f32 v18, s35, v18
    v_mul_f32 v19, s35, v19
    v_cvt_pk_bf16_f32 v26, v20, v21
    v_lshlrev_b32 v20, 16, v26
    v_and_b32 v21, 0xffff0000, v26
    v_mul_f32 v20, s34, v20
    v_mul_f32 v21, s34, v21
    v_cvt_pk_bf16_f32 v26, v20, v21
    v_lshlrev_b32 v20, 16, v26
    v_and_b32 v21, 0xffff0000, v26
    v_mul_f32 v20, s35, v20
    v_mul_f32 v21, s35, v21
    v_cvt_pk_bf16_f32 v26, v22, v23
    v_lshlrev_b32 v22, 16, v26
    v_and_b32 v23, 0xffff0000, v26
    v_mul_f32 v22, s34, v22
    v_mul_f32 v23, s34, v23
    v_cvt_pk_bf16_f32 v26, v22, v23
    v_lshlrev_b32 v22, 16, v26
    v_and_b32 v23, 0xffff0000, v26
    v_mul_f32 v22, s35, v22
    v_mul_f32 v23, s35, v23
    v_cvt_pk_bf16_f32 v26, v24, v25
    v_lshlrev_b32 v24, 16, v26
    v_and_b32 v25, 0xffff0000, v26
    v_mul_f32 v24, s34, v24
    v_mul_f32 v25, s34, v25
    v_cvt_pk_bf16_f32 v26, v24, v25
    v_lshlrev_b32 v24, 16, v26
    v_and_b32 v25, 0xffff0000, v26
    v_mul_f32 v24, s35, v24
    v_mul_f32 v25, s35, v25
    v_max3_f32 v26, v18, v19, v20
    v_max3_f32 v26, v26, v21, v22
    v_max3_f32 v26, v26, v23, v24
    v_max3_f32 v26, v26, v25, v8
    v_sub_f32 v27, v8, v26
    v_exp_f32 v27, v27
    v_mov_b32 v8, v26
    v_sub_f32 v18, v18, v26
    v_sub_f32 v19, v19, v26
    v_sub_f32 v20, v20, v26
    v_sub_f32 v21, v21, v26
    v_sub_f32 v22, v22, v26
    v_sub_f32 v23, v23, v26
    v_sub_f32 v24, v24, v26
    v_sub_f32 v25, v25, v26
    v_exp_f32 v18, v18
    v_exp_f32 v19, v19
    v_exp_f32 v20, v20
    v_exp_f32 v21, v21
    v_exp_f32 v22, v22
    v_exp_f32 v23, v23
    v_exp_f32 v24, v24
    v_exp_f32 v25, v25
    v_mul_f32 v9, v9, v27
    v_mul_f32 v10, v10, v27
    v_mul_f32 v11, v11, v27
    v_mul_f32 v12, v12, v27
    v_mul_f32 v13, v13, v27
    v_mul_f32 v14, v14, v27
    v_mul_f32 v15, v15, v27
    v_mul_f32 v16, v16, v27
    v_mul_f32 v17, v17, v27
    v_add_f32 v9, v9, v18
    v_add_f32 v9, v9, v19
    v_add_f32 v9, v9, v20
    v_add_f32 v9, v9, v21
    v_add_f32 v9, v9, v22
    v_add_f32 v9, v9, v23
    v_add_f32 v9, v9, v24
    v_add_f32 v9, v9, v25
    v_lshlrev_b32 v34, 16, v160
    v_and_b32 v35, 0xffff0000, v160
    v_lshlrev_b32 v36, 16, v161
    v_and_b32 v37, 0xffff0000, v161
    v_lshlrev_b32 v38, 16, v162
    v_and_b32 v39, 0xffff0000, v162
    v_lshlrev_b32 v40, 16, v163
    v_and_b32 v41, 0xffff0000, v163
    v_fmac_f32 v10, v34, v18
    v_fmac_f32 v11, v35, v18
    v_fmac_f32 v12, v36, v18
    v_fmac_f32 v13, v37, v18
    v_fmac_f32 v14, v38, v18
    v_fmac_f32 v15, v39, v18
    v_fmac_f32 v16, v40, v18
    v_fmac_f32 v17, v41, v18
    v_lshlrev_b32 v34, 16, v164
    v_and_b32 v35, 0xffff0000, v164
    v_lshlrev_b32 v36, 16, v165
    v_and_b32 v37, 0xffff0000, v165
    v_lshlrev_b32 v38, 16, v166
    v_and_b32 v39, 0xffff0000, v166
    v_lshlrev_b32 v40, 16, v167
    v_and_b32 v41, 0xffff0000, v167
    v_fmac_f32 v10, v34, v19
    v_fmac_f32 v11, v35, v19
    v_fmac_f32 v12, v36, v19
    v_fmac_f32 v13, v37, v19
    v_fmac_f32 v14, v38, v19
    v_fmac_f32 v15, v39, v19
    v_fmac_f32 v16, v40, v19
    v_fmac_f32 v17, v41, v19
    v_lshlrev_b32 v34, 16, v168
    v_and_b32 v35, 0xffff0000, v168
    v_lshlrev_b32 v36, 16, v169
    v_and_b32 v37, 0xffff0000, v169
    v_lshlrev_b32 v38, 16, v170
    v_and_b32 v39, 0xffff0000, v170
    v_lshlrev_b32 v40, 16, v171
    v_and_b32 v41, 0xffff0000, v171
    v_fmac_f32 v10, v34, v20
    v_fmac_f32 v11, v35, v20
    v_fmac_f32 v12, v36, v20
    v_fmac_f32 v13, v37, v20
    v_fmac_f32 v14, v38, v20
    v_fmac_f32 v15, v39, v20
    v_fmac_f32 v16, v40, v20
    v_fmac_f32 v17, v41, v20
    v_lshlrev_b32 v34, 16, v172
    v_and_b32 v35, 0xffff0000, v172
    v_lshlrev_b32 v36, 16, v173
    v_and_b32 v37, 0xffff0000, v173
    v_lshlrev_b32 v38, 16, v174
    v_and_b32 v39, 0xffff0000, v174
    v_lshlrev_b32 v40, 16, v175
    v_and_b32 v41, 0xffff0000, v175
    v_fmac_f32 v10, v34, v21
    v_fmac_f32 v11, v35, v21
    v_fmac_f32 v12, v36, v21
    v_fmac_f32 v13, v37, v21
    v_fmac_f32 v14, v38, v21
    v_fmac_f32 v15, v39, v21
    v_fmac_f32 v16, v40, v21
    v_fmac_f32 v17, v41, v21
    v_lshlrev_b32 v34, 16, v176
    v_and_b32 v35, 0xffff0000, v176
    v_lshlrev_b32 v36, 16, v177
    v_and_b32 v37, 0xffff0000, v177
    v_lshlrev_b32 v38, 16, v178
    v_and_b32 v39, 0xffff0000, v178
    v_lshlrev_b32 v40, 16, v179
    v_and_b32 v41, 0xffff0000, v179
    v_fmac_f32 v10, v34, v22
    v_fmac_f32 v11, v35, v22
    v_fmac_f32 v12, v36, v22
    v_fmac_f32 v13, v37, v22
    v_fmac_f32 v14, v38, v22
    v_fmac_f32 v15, v39, v22
    v_fmac_f32 v16, v40, v22
    v_fmac_f32 v17, v41, v22
    v_lshlrev_b32 v34, 16, v180
    v_and_b32 v35, 0xffff0000, v180
    v_lshlrev_b32 v36, 16, v181
    v_and_b32 v37, 0xffff0000, v181
    v_lshlrev_b32 v38, 16, v182
    v_and_b32 v39, 0xffff0000, v182
    v_lshlrev_b32 v40, 16, v183
    v_and_b32 v41, 0xffff0000, v183
    v_fmac_f32 v10, v34, v23
    v_fmac_f32 v11, v35, v23
    v_fmac_f32 v12, v36, v23
    v_fmac_f32 v13, v37, v23
    v_fmac_f32 v14, v38, v23
    v_fmac_f32 v15, v39, v23
    v_fmac_f32 v16, v40, v23
    v_fmac_f32 v17, v41, v23
    v_lshlrev_b32 v34, 16, v184
    v_and_b32 v35, 0xffff0000, v184
    v_lshlrev_b32 v36, 16, v185
    v_and_b32 v37, 0xffff0000, v185
    v_lshlrev_b32 v38, 16, v186
    v_and_b32 v39, 0xffff0000, v186
    v_lshlrev_b32 v40, 16, v187
    v_and_b32 v41, 0xffff0000, v187
    v_fmac_f32 v10, v34, v24
    v_fmac_f32 v11, v35, v24
    v_fmac_f32 v12, v36, v24
    v_fmac_f32 v13, v37, v24
    v_fmac_f32 v14, v38, v24
    v_fmac_f32 v15, v39, v24
    v_fmac_f32 v16, v40, v24
    v_fmac_f32 v17, v41, v24
    v_lshlrev_b32 v34, 16, v188
    v_and_b32 v35, 0xffff0000, v188
    v_lshlrev_b32 v36, 16, v189
    v_and_b32 v37, 0xffff0000, v189
    v_lshlrev_b32 v38, 16, v190
    v_and_b32 v39, 0xffff0000, v190
    v_lshlrev_b32 v40, 16, v191
    v_and_b32 v41, 0xffff0000, v191
    v_fmac_f32 v10, v34, v25
    v_fmac_f32 v11, v35, v25
    v_fmac_f32 v12, v36, v25
    v_fmac_f32 v13, v37, v25
    v_fmac_f32 v14, v38, v25
    v_fmac_f32 v15, v39, v25
    v_fmac_f32 v16, v40, v25
    v_fmac_f32 v17, v41, v25
    v_accvgpr_read_b32 v192, a128
    v_accvgpr_read_b32 v193, a129
    v_accvgpr_read_b32 v194, a130
    v_accvgpr_read_b32 v195, a131
    v_accvgpr_read_b32 v196, a132
    v_accvgpr_read_b32 v197, a133
    v_accvgpr_read_b32 v198, a134
    v_accvgpr_read_b32 v199, a135
    v_accvgpr_read_b32 v200, a136
    v_accvgpr_read_b32 v201, a137
    v_accvgpr_read_b32 v202, a138
    v_accvgpr_read_b32 v203, a139
    v_accvgpr_read_b32 v204, a140
    v_accvgpr_read_b32 v205, a141
    v_accvgpr_read_b32 v206, a142
    v_accvgpr_read_b32 v207, a143
    v_accvgpr_read_b32 v208, a144
    v_accvgpr_read_b32 v209, a145
    v_accvgpr_read_b32 v210, a146
    v_accvgpr_read_b32 v211, a147
    v_accvgpr_read_b32 v212, a148
    v_accvgpr_read_b32 v213, a149
    v_accvgpr_read_b32 v214, a150
    v_accvgpr_read_b32 v215, a151
    v_accvgpr_read_b32 v216, a152
    v_accvgpr_read_b32 v217, a153
    v_accvgpr_read_b32 v218, a154
    v_accvgpr_read_b32 v219, a155
    v_accvgpr_read_b32 v220, a156
    v_accvgpr_read_b32 v221, a157
    v_accvgpr_read_b32 v222, a158
    v_accvgpr_read_b32 v223, a159
    v_accvgpr_read_b32 v224, a160
    v_accvgpr_read_b32 v225, a161
    v_accvgpr_read_b32 v226, a162
    v_accvgpr_read_b32 v227, a163
    v_accvgpr_read_b32 v228, a164
    v_accvgpr_read_b32 v229, a165
    v_accvgpr_read_b32 v230, a166
    v_accvgpr_read_b32 v231, a167
    v_accvgpr_read_b32 v232, a168
    v_accvgpr_read_b32 v233, a169
    v_accvgpr_read_b32 v234, a170
    v_accvgpr_read_b32 v235, a171
    v_accvgpr_read_b32 v236, a172
    v_accvgpr_read_b32 v237, a173
    v_accvgpr_read_b32 v238, a174
    v_accvgpr_read_b32 v239, a175
    v_accvgpr_read_b32 v240, a176
    v_accvgpr_read_b32 v241, a177
    v_accvgpr_read_b32 v242, a178
    v_accvgpr_read_b32 v243, a179
    v_accvgpr_read_b32 v244, a180
    v_accvgpr_read_b32 v245, a181
    v_accvgpr_read_b32 v246, a182
    v_accvgpr_read_b32 v247, a183
    v_accvgpr_read_b32 v248, a184
    v_accvgpr_read_b32 v249, a185
    v_accvgpr_read_b32 v250, a186
    v_accvgpr_read_b32 v251, a187
    v_accvgpr_read_b32 v252, a188
    v_accvgpr_read_b32 v253, a189
    v_accvgpr_read_b32 v254, a190
    v_accvgpr_read_b32 v255, a191
    v_dot2_f32_bf16 v18, v192, v2, 0
    v_dot2_f32_bf16 v19, v196, v2, 0
    v_dot2_f32_bf16 v20, v200, v2, 0
    v_dot2_f32_bf16 v21, v204, v2, 0
    v_dot2_f32_bf16 v22, v208, v2, 0
    v_dot2_f32_bf16 v23, v212, v2, 0
    v_dot2_f32_bf16 v24, v216, v2, 0
    v_dot2_f32_bf16 v25, v220, v2, 0
    v_dot2_f32_bf16 v18, v193, v3, v18
    v_dot2_f32_bf16 v19, v197, v3, v19
    v_dot2_f32_bf16 v20, v201, v3, v20
    v_dot2_f32_bf16 v21, v205, v3, v21
    v_dot2_f32_bf16 v22, v209, v3, v22
    v_dot2_f32_bf16 v23, v213, v3, v23
    v_dot2_f32_bf16 v24, v217, v3, v24
    v_dot2_f32_bf16 v25, v221, v3, v25
    v_dot2_f32_bf16 v18, v194, v4, v18
    v_dot2_f32_bf16 v19, v198, v4, v19
    v_dot2_f32_bf16 v20, v202, v4, v20
    v_dot2_f32_bf16 v21, v206, v4, v21
    v_dot2_f32_bf16 v22, v210, v4, v22
    v_dot2_f32_bf16 v23, v214, v4, v23
    v_dot2_f32_bf16 v24, v218, v4, v24
    v_dot2_f32_bf16 v25, v222, v4, v25
    v_dot2_f32_bf16 v18, v195, v5, v18
    v_dot2_f32_bf16 v19, v199, v5, v19
    v_dot2_f32_bf16 v20, v203, v5, v20
    v_dot2_f32_bf16 v21, v207, v5, v21
    v_dot2_f32_bf16 v22, v211, v5, v22
    v_dot2_f32_bf16 v23, v215, v5, v23
    v_dot2_f32_bf16 v24, v219, v5, v24
    v_dot2_f32_bf16 v25, v223, v5, v25
    v_add_f32_dpp v18, v18, v18 row_ror:8 row_mask:0xf bank_mask:0xf
    v_add_f32_dpp v19, v19, v19 row_ror:8 row_mask:0xf bank_mask:0xf
    v_add_f32_dpp v20, v20, v20 row_ror:8 row_mask:0xf bank_mask:0xf
    v_add_f32_dpp v21, v21, v21 row_ror:8 row_mask:0xf bank_mask:0xf
    v_add_f32_dpp v22, v22, v22 row_ror:8 row_mask:0xf bank_mask:0xf
    v_add_f32_dpp v23, v23, v23 row_ror:8 row_mask:0xf bank_mask:0xf
    v_add_f32_dpp v24, v24, v24 row_ror:8 row_mask:0xf bank_mask:0xf
    v_add_f32_dpp v25, v25, v25 row_ror:8 row_mask:0xf bank_mask:0xf
    v_add_f32_dpp v18, v18, v18 row_ror:4 row_mask:0xf bank_mask:0xf
    v_add_f32_dpp v19, v19, v19 row_ror:4 row_mask:0xf bank_mask:0xf
    v_add_f32_dpp v20, v20, v20 row_ror:4 row_mask:0xf bank_mask:0xf
    v_add_f32_dpp v21, v21, v21 row_ror:4 row_mask:0xf bank_mask:0xf
    v_add_f32_dpp v22, v22, v22 row_ror:4 row_mask:0xf bank_mask:0xf
    v_add_f32_dpp v23, v23, v23 row_ror:4 row_mask:0xf bank_mask:0xf
    v_add_f32_dpp v24, v24, v24 row_ror:4 row_mask:0xf bank_mask:0xf
    v_add_f32_dpp v25, v25, v25 row_ror:4 row_mask:0xf bank_mask:0xf
    v_add_f32_dpp v18, v18, v18 row_ror:2 row_mask:0xf bank_mask:0xf
    v_add_f32_dpp v19, v19, v19 row_ror:2 row_mask:0xf bank_mask:0xf
    v_add_f32_dpp v20, v20, v20 row_ror:2 row_mask:0xf bank_mask:0xf
    v_add_f32_dpp v21, v21, v21 row_ror:2 row_mask:0xf bank_mask:0xf
    v_add_f32_dpp v22, v22, v22 row_ror:2 row_mask:0xf bank_mask:0xf
    v_add_f32_dpp v23, v23, v23 row_ror:2 row_mask:0xf bank_mask:0xf
    v_add_f32_dpp v24, v24, v24 row_ror:2 row_mask:0xf bank_mask:0xf
    v_add_f32_dpp v25, v25, v25 row_ror:2 row_mask:0xf bank_mask:0xf
    v_add_f32_dpp v18, v18, v18 row_ror:1 row_mask:0xf bank_mask:0xf
    v_add_f32_dpp v19, v19, v19 row_ror:1 row_mask:0xf bank_mask:0xf
    v_add_f32_dpp v20, v20, v20 row_ror:1 row_mask:0xf bank_mask:0xf
    v_add_f32_dpp v21, v21, v21 row_ror:1 row_mask:0xf bank_mask:0xf
    v_add_f32_dpp v22, v22, v22 row_ror:1 row_mask:0xf bank_mask:0xf
    v_add_f32_dpp v23, v23, v23 row_ror:1 row_mask:0xf bank_mask:0xf
    v_add_f32_dpp v24, v24, v24 row_ror:1 row_mask:0xf bank_mask:0xf
    v_add_f32_dpp v25, v25, v25 row_ror:1 row_mask:0xf bank_mask:0xf
    v_cvt_pk_bf16_f32 v26, v18, v19
    v_lshlrev_b32 v18, 16, v26
    v_and_b32 v19, 0xffff0000, v26
    v_mul_f32 v18, s34, v18
    v_mul_f32 v19, s34, v19
    v_cvt_pk_bf16_f32 v26, v18, v19
    v_lshlrev_b32 v18, 16, v26
    v_and_b32 v19, 0xffff0000, v26
    v_mul_f32 v18, s35, v18
    v_mul_f32 v19, s35, v19
    v_cvt_pk_bf16_f32 v26, v20, v21
    v_lshlrev_b32 v20, 16, v26
    v_and_b32 v21, 0xffff0000, v26
    v_mul_f32 v20, s34, v20
    v_mul_f32 v21, s34, v21
    v_cvt_pk_bf16_f32 v26, v20, v21
    v_lshlrev_b32 v20, 16, v26
    v_and_b32 v21, 0xffff0000, v26
    v_mul_f32 v20, s35, v20
    v_mul_f32 v21, s35, v21
    v_cvt_pk_bf16_f32 v26, v22, v23
    v_lshlrev_b32 v22, 16, v26
    v_and_b32 v23, 0xffff0000, v26
    v_mul_f32 v22, s34, v22
    v_mul_f32 v23, s34, v23
    v_cvt_pk_bf16_f32 v26, v22, v23
    v_lshlrev_b32 v22, 16, v26
    v_and_b32 v23, 0xffff0000, v26
    v_mul_f32 v22, s35, v22
    v_mul_f32 v23, s35, v23
    v_cvt_pk_bf16_f32 v26, v24, v25
    v_lshlrev_b32 v24, 16, v26
    v_and_b32 v25, 0xffff0000, v26
    v_mul_f32 v24, s34, v24
    v_mul_f32 v25, s34, v25
    v_cvt_pk_bf16_f32 v26, v24, v25
    v_lshlrev_b32 v24, 16, v26
    v_and_b32 v25, 0xffff0000, v26
    v_mul_f32 v24, s35, v24
    v_mul_f32 v25, s35, v25
    v_max3_f32 v26, v18, v19, v20
    v_max3_f32 v26, v26, v21, v22
    v_max3_f32 v26, v26, v23, v24
    v_max3_f32 v26, v26, v25, v8
    v_sub_f32 v27, v8, v26
    v_exp_f32 v27, v27
    v_mov_b32 v8, v26
    v_sub_f32 v18, v18, v26
    v_sub_f32 v19, v19, v26
    v_sub_f32 v20, v20, v26
    v_sub_f32 v21, v21, v26
    v_sub_f32 v22, v22, v26
    v_sub_f32 v23, v23, v26
    v_sub_f32 v24, v24, v26
    v_sub_f32 v25, v25, v26
    v_exp_f32 v18, v18
    v_exp_f32 v19, v19
    v_exp_f32 v20, v20
    v_exp_f32 v21, v21
    v_exp_f32 v22, v22
    v_exp_f32 v23, v23
    v_exp_f32 v24, v24
    v_exp_f32 v25, v25
    v_mul_f32 v9, v9, v27
    v_mul_f32 v10, v10, v27
    v_mul_f32 v11, v11, v27
    v_mul_f32 v12, v12, v27
    v_mul_f32 v13, v13, v27
    v_mul_f32 v14, v14, v27
    v_mul_f32 v15, v15, v27
    v_mul_f32 v16, v16, v27
    v_mul_f32 v17, v17, v27
    v_add_f32 v9, v9, v18
    v_add_f32 v9, v9, v19
    v_add_f32 v9, v9, v20
    v_add_f32 v9, v9, v21
    v_add_f32 v9, v9, v22
    v_add_f32 v9, v9, v23
    v_add_f32 v9, v9, v24
    v_add_f32 v9, v9, v25
    v_lshlrev_b32 v34, 16, v224
    v_and_b32 v35, 0xffff0000, v224
    v_lshlrev_b32 v36, 16, v225
    v_and_b32 v37, 0xffff0000, v225
    v_lshlrev_b32 v38, 16, v226
    v_and_b32 v39, 0xffff0000, v226
    v_lshlrev_b32 v40, 16, v227
    v_and_b32 v41, 0xffff0000, v227
    v_fmac_f32 v10, v34, v18
    v_fmac_f32 v11, v35, v18
    v_fmac_f32 v12, v36, v18
    v_fmac_f32 v13, v37, v18
    v_fmac_f32 v14, v38, v18
    v_fmac_f32 v15, v39, v18
    v_fmac_f32 v16, v40, v18
    v_fmac_f32 v17, v41, v18
    v_lshlrev_b32 v34, 16, v228
    v_and_b32 v35, 0xffff0000, v228
    v_lshlrev_b32 v36, 16, v229
    v_and_b32 v37, 0xffff0000, v229
    v_lshlrev_b32 v38, 16, v230
    v_and_b32 v39, 0xffff0000, v230
    v_lshlrev_b32 v40, 16, v231
    v_and_b32 v41, 0xffff0000, v231
    v_fmac_f32 v10, v34, v19
    v_fmac_f32 v11, v35, v19
    v_fmac_f32 v12, v36, v19
    v_fmac_f32 v13, v37, v19
    v_fmac_f32 v14, v38, v19
    v_fmac_f32 v15, v39, v19
    v_fmac_f32 v16, v40, v19
    v_fmac_f32 v17, v41, v19
    v_lshlrev_b32 v34, 16, v232
    v_and_b32 v35, 0xffff0000, v232
    v_lshlrev_b32 v36, 16, v233
    v_and_b32 v37, 0xffff0000, v233
    v_lshlrev_b32 v38, 16, v234
    v_and_b32 v39, 0xffff0000, v234
    v_lshlrev_b32 v40, 16, v235
    v_and_b32 v41, 0xffff0000, v235
    v_fmac_f32 v10, v34, v20
    v_fmac_f32 v11, v35, v20
    v_fmac_f32 v12, v36, v20
    v_fmac_f32 v13, v37, v20
    v_fmac_f32 v14, v38, v20
    v_fmac_f32 v15, v39, v20
    v_fmac_f32 v16, v40, v20
    v_fmac_f32 v17, v41, v20
    v_lshlrev_b32 v34, 16, v236
    v_and_b32 v35, 0xffff0000, v236
    v_lshlrev_b32 v36, 16, v237
    v_and_b32 v37, 0xffff0000, v237
    v_lshlrev_b32 v38, 16, v238
    v_and_b32 v39, 0xffff0000, v238
    v_lshlrev_b32 v40, 16, v239
    v_and_b32 v41, 0xffff0000, v239
    v_fmac_f32 v10, v34, v21
    v_fmac_f32 v11, v35, v21
    v_fmac_f32 v12, v36, v21
    v_fmac_f32 v13, v37, v21
    v_fmac_f32 v14, v38, v21
    v_fmac_f32 v15, v39, v21
    v_fmac_f32 v16, v40, v21
    v_fmac_f32 v17, v41, v21
    v_lshlrev_b32 v34, 16, v240
    v_and_b32 v35, 0xffff0000, v240
    v_lshlrev_b32 v36, 16, v241
    v_and_b32 v37, 0xffff0000, v241
    v_lshlrev_b32 v38, 16, v242
    v_and_b32 v39, 0xffff0000, v242
    v_lshlrev_b32 v40, 16, v243
    v_and_b32 v41, 0xffff0000, v243
    v_fmac_f32 v10, v34, v22
    v_fmac_f32 v11, v35, v22
    v_fmac_f32 v12, v36, v22
    v_fmac_f32 v13, v37, v22
    v_fmac_f32 v14, v38, v22
    v_fmac_f32 v15, v39, v22
    v_fmac_f32 v16, v40, v22
    v_fmac_f32 v17, v41, v22
    v_lshlrev_b32 v34, 16, v244
    v_and_b32 v35, 0xffff0000, v244
    v_lshlrev_b32 v36, 16, v245
    v_and_b32 v37, 0xffff0000, v245
    v_lshlrev_b32 v38, 16, v246
    v_and_b32 v39, 0xffff0000, v246
    v_lshlrev_b32 v40, 16, v247
    v_and_b32 v41, 0xffff0000, v247
    v_fmac_f32 v10, v34, v23
    v_fmac_f32 v11, v35, v23
    v_fmac_f32 v12, v36, v23
    v_fmac_f32 v13, v37, v23
    v_fmac_f32 v14, v38, v23
    v_fmac_f32 v15, v39, v23
    v_fmac_f32 v16, v40, v23
    v_fmac_f32 v17, v41, v23
    v_lshlrev_b32 v34, 16, v248
    v_and_b32 v35, 0xffff0000, v248
    v_lshlrev_b32 v36, 16, v249
    v_and_b32 v37, 0xffff0000, v249
    v_lshlrev_b32 v38, 16, v250
    v_and_b32 v39, 0xffff0000, v250
    v_lshlrev_b32 v40, 16, v251
    v_and_b32 v41, 0xffff0000, v251
    v_fmac_f32 v10, v34, v24
    v_fmac_f32 v11, v35, v24
    v_fmac_f32 v12, v36, v24
    v_fmac_f32 v13, v37, v24
    v_fmac_f32 v14, v38, v24
    v_fmac_f32 v15, v39, v24
    v_fmac_f32 v16, v40, v24
    v_fmac_f32 v17, v41, v24
    v_lshlrev_b32 v34, 16, v252
    v_and_b32 v35, 0xffff0000, v252
    v_lshlrev_b32 v36, 16, v253
    v_and_b32 v37, 0xffff0000, v253
    v_lshlrev_b32 v38, 16, v254
    v_and_b32 v39, 0xffff0000, v254
    v_lshlrev_b32 v40, 16, v255
    v_and_b32 v41, 0xffff0000, v255
    v_fmac_f32 v10, v34, v25
    v_fmac_f32 v11, v35, v25
    v_fmac_f32 v12, v36, v25
    v_fmac_f32 v13, v37, v25
    v_fmac_f32 v14, v38, v25
    v_fmac_f32 v15, v39, v25
    v_fmac_f32 v16, v40, v25
    v_fmac_f32 v17, v41, v25
    s_branch KM_BFIN
KM_BONLY:
    s_sub_u32 s27, s25, 2
    s_mul_i32 s27, s27, 196608
    s_add_u32 s31, s30, s27
    s_sub_u32 s31, s31, 32768
    v_mov_b32 v8, 0xff800000
    v_mov_b32 v9, 0
    v_mov_b32 v10, 0
    v_mov_b32 v11, 0
    v_mov_b32 v12, 0
    v_mov_b32 v13, 0
    v_mov_b32 v14, 0
    v_mov_b32 v15, 0
    v_mov_b32 v16, 0
    v_mov_b32 v17, 0
    s_add_u32 s31, s31, 32768
    s_mov_b32 s60, s31
    buffer_load_dwordx4 v[128:131], v6, s[12:15], s60 offen offset:0 nt
    buffer_load_dwordx4 v[132:135], v6, s[12:15], s60 offen offset:1024 nt
    buffer_load_dwordx4 v[136:139], v6, s[12:15], s60 offen offset:2048 nt
    buffer_load_dwordx4 v[140:143], v6, s[12:15], s60 offen offset:3072 nt
    buffer_load_dwordx4 v[144:147], v7, s[12:15], s60 offen offset:0 nt
    buffer_load_dwordx4 v[148:151], v7, s[12:15], s60 offen offset:1024 nt
    buffer_load_dwordx4 v[152:155], v7, s[12:15], s60 offen offset:2048 nt
    buffer_load_dwordx4 v[156:159], v7, s[12:15], s60 offen offset:3072 nt
    buffer_load_dwordx4 v[160:163], v6, s[16:19], s60 offen offset:0 nt
    buffer_load_dwordx4 v[164:167], v6, s[16:19], s60 offen offset:1024 nt
    buffer_load_dwordx4 v[168:171], v6, s[16:19], s60 offen offset:2048 nt
    buffer_load_dwordx4 v[172:175], v6, s[16:19], s60 offen offset:3072 nt
    buffer_load_dwordx4 v[176:179], v7, s[16:19], s60 offen offset:0 nt
    buffer_load_dwordx4 v[180:183], v7, s[16:19], s60 offen offset:1024 nt
    buffer_load_dwordx4 v[184:187], v7, s[16:19], s60 offen offset:2048 nt
    buffer_load_dwordx4 v[188:191], v7, s[16:19], s60 offen offset:3072 nt
    s_add_u32 s31, s31, 32768
    s_mov_b32 s61, s31
    buffer_load_dwordx4 v[192:195], v6, s[12:15], s61 offen offset:0 nt
    buffer_load_dwordx4 v[196:199], v6, s[12:15], s61 offen offset:1024 nt
    buffer_load_dwordx4 v[200:203], v6, s[12:15], s61 offen offset:2048 nt
    buffer_load_dwordx4 v[204:207], v6, s[12:15], s61 offen offset:3072 nt
    buffer_load_dwordx4 v[208:211], v7, s[12:15], s61 offen offset:0 nt
    buffer_load_dwordx4 v[212:215], v7, s[12:15], s61 offen offset:1024 nt
    buffer_load_dwordx4 v[216:219], v7, s[12:15], s61 offen offset:2048 nt
    buffer_load_dwordx4 v[220:223], v7, s[12:15], s61 offen offset:3072 nt
    buffer_load_dwordx4 v[224:227], v6, s[16:19], s61 offen offset:0 nt
    buffer_load_dwordx4 v[228:231], v6, s[16:19], s61 offen offset:1024 nt
    buffer_load_dwordx4 v[232:235], v6, s[16:19], s61 offen offset:2048 nt
    buffer_load_dwordx4 v[236:239], v6, s[16:19], s61 offen offset:3072 nt
    buffer_load_dwordx4 v[240:243], v7, s[16:19], s61 offen offset:0 nt
    buffer_load_dwordx4 v[244:247], v7, s[16:19], s61 offen offset:1024 nt
    buffer_load_dwordx4 v[248:251], v7, s[16:19], s61 offen offset:2048 nt
    buffer_load_dwordx4 v[252:255], v7, s[16:19], s61 offen offset:3072 nt
    s_waitcnt vmcnt(32)
    v_add_f32 v44, v44, v45
    v_add_f32 v46, v46, v47
    v_add_f32 v44, v44, v46
    v_cvt_pk_bf16_f32 v44, v44, v44
    v_lshrrev_b32 v42, 1, v42
    v_add_u32 v42, 134144, v42
    ds_write_b16 v42, v44
    s_waitcnt lgkmcnt(0)
    s_barrier
    v_and_b32 v43, 15, v1
    v_lshlrev_b32 v43, 4, v43
    v_add_u32 v43, 134144, v43
    ds_read_b128 v[2:5], v43
    s_waitcnt lgkmcnt(0)
    s_waitcnt vmcnt(24)
    v_dot2_f32_bf16 v18, v128, v2, 0
    v_dot2_f32_bf16 v19, v132, v2, 0
    v_dot2_f32_bf16 v20, v136, v2, 0
    v_dot2_f32_bf16 v21, v140, v2, 0
    v_dot2_f32_bf16 v22, v144, v2, 0
    v_dot2_f32_bf16 v23, v148, v2, 0
    v_dot2_f32_bf16 v24, v152, v2, 0
    v_dot2_f32_bf16 v25, v156, v2, 0
    v_dot2_f32_bf16 v18, v129, v3, v18
    v_dot2_f32_bf16 v19, v133, v3, v19
    v_dot2_f32_bf16 v20, v137, v3, v20
    v_dot2_f32_bf16 v21, v141, v3, v21
    v_dot2_f32_bf16 v22, v145, v3, v22
    v_dot2_f32_bf16 v23, v149, v3, v23
    v_dot2_f32_bf16 v24, v153, v3, v24
    v_dot2_f32_bf16 v25, v157, v3, v25
    v_dot2_f32_bf16 v18, v130, v4, v18
    v_dot2_f32_bf16 v19, v134, v4, v19
    v_dot2_f32_bf16 v20, v138, v4, v20
    v_dot2_f32_bf16 v21, v142, v4, v21
    v_dot2_f32_bf16 v22, v146, v4, v22
    v_dot2_f32_bf16 v23, v150, v4, v23
    v_dot2_f32_bf16 v24, v154, v4, v24
    v_dot2_f32_bf16 v25, v158, v4, v25
    v_dot2_f32_bf16 v18, v131, v5, v18
    v_dot2_f32_bf16 v19, v135, v5, v19
    v_dot2_f32_bf16 v20, v139, v5, v20
    v_dot2_f32_bf16 v21, v143, v5, v21
    v_dot2_f32_bf16 v22, v147, v5, v22
    v_dot2_f32_bf16 v23, v151, v5, v23
    v_dot2_f32_bf16 v24, v155, v5, v24
    v_dot2_f32_bf16 v25, v159, v5, v25
    v_add_f32_dpp v18, v18, v18 row_ror:8 row_mask:0xf bank_mask:0xf
    v_add_f32_dpp v19, v19, v19 row_ror:8 row_mask:0xf bank_mask:0xf
    v_add_f32_dpp v20, v20, v20 row_ror:8 row_mask:0xf bank_mask:0xf
    v_add_f32_dpp v21, v21, v21 row_ror:8 row_mask:0xf bank_mask:0xf
    v_add_f32_dpp v22, v22, v22 row_ror:8 row_mask:0xf bank_mask:0xf
    v_add_f32_dpp v23, v23, v23 row_ror:8 row_mask:0xf bank_mask:0xf
    v_add_f32_dpp v24, v24, v24 row_ror:8 row_mask:0xf bank_mask:0xf
    v_add_f32_dpp v25, v25, v25 row_ror:8 row_mask:0xf bank_mask:0xf
    v_add_f32_dpp v18, v18, v18 row_ror:4 row_mask:0xf bank_mask:0xf
    v_add_f32_dpp v19, v19, v19 row_ror:4 row_mask:0xf bank_mask:0xf
    v_add_f32_dpp v20, v20, v20 row_ror:4 row_mask:0xf bank_mask:0xf
    v_add_f32_dpp v21, v21, v21 row_ror:4 row_mask:0xf bank_mask:0xf
    v_add_f32_dpp v22, v22, v22 row_ror:4 row_mask:0xf bank_mask:0xf
    v_add_f32_dpp v23, v23, v23 row_ror:4 row_mask:0xf bank_mask:0xf
    v_add_f32_dpp v24, v24, v24 row_ror:4 row_mask:0xf bank_mask:0xf
    v_add_f32_dpp v25, v25, v25 row_ror:4 row_mask:0xf bank_mask:0xf
    v_add_f32_dpp v18, v18, v18 row_ror:2 row_mask:0xf bank_mask:0xf
    v_add_f32_dpp v19, v19, v19 row_ror:2 row_mask:0xf bank_mask:0xf
    v_add_f32_dpp v20, v20, v20 row_ror:2 row_mask:0xf bank_mask:0xf
    v_add_f32_dpp v21, v21, v21 row_ror:2 row_mask:0xf bank_mask:0xf
    v_add_f32_dpp v22, v22, v22 row_ror:2 row_mask:0xf bank_mask:0xf
    v_add_f32_dpp v23, v23, v23 row_ror:2 row_mask:0xf bank_mask:0xf
    v_add_f32_dpp v24, v24, v24 row_ror:2 row_mask:0xf bank_mask:0xf
    v_add_f32_dpp v25, v25, v25 row_ror:2 row_mask:0xf bank_mask:0xf
    v_add_f32_dpp v18, v18, v18 row_ror:1 row_mask:0xf bank_mask:0xf
    v_add_f32_dpp v19, v19, v19 row_ror:1 row_mask:0xf bank_mask:0xf
    v_add_f32_dpp v20, v20, v20 row_ror:1 row_mask:0xf bank_mask:0xf
    v_add_f32_dpp v21, v21, v21 row_ror:1 row_mask:0xf bank_mask:0xf
    v_add_f32_dpp v22, v22, v22 row_ror:1 row_mask:0xf bank_mask:0xf
    v_add_f32_dpp v23, v23, v23 row_ror:1 row_mask:0xf bank_mask:0xf
    v_add_f32_dpp v24, v24, v24 row_ror:1 row_mask:0xf bank_mask:0xf
    v_add_f32_dpp v25, v25, v25 row_ror:1 row_mask:0xf bank_mask:0xf
    v_cvt_pk_bf16_f32 v26, v18, v19
    v_lshlrev_b32 v18, 16, v26
    v_and_b32 v19, 0xffff0000, v26
    v_mul_f32 v18, s34, v18
    v_mul_f32 v19, s34, v19
    v_cvt_pk_bf16_f32 v26, v18, v19
    v_lshlrev_b32 v18, 16, v26
    v_and_b32 v19, 0xffff0000, v26
    v_mul_f32 v18, s35, v18
    v_mul_f32 v19, s35, v19
    v_cvt_pk_bf16_f32 v26, v20, v21
    v_lshlrev_b32 v20, 16, v26
    v_and_b32 v21, 0xffff0000, v26
    v_mul_f32 v20, s34, v20
    v_mul_f32 v21, s34, v21
    v_cvt_pk_bf16_f32 v26, v20, v21
    v_lshlrev_b32 v20, 16, v26
    v_and_b32 v21, 0xffff0000, v26
    v_mul_f32 v20, s35, v20
    v_mul_f32 v21, s35, v21
    v_cvt_pk_bf16_f32 v26, v22, v23
    v_lshlrev_b32 v22, 16, v26
    v_and_b32 v23, 0xffff0000, v26
    v_mul_f32 v22, s34, v22
    v_mul_f32 v23, s34, v23
    v_cvt_pk_bf16_f32 v26, v22, v23
    v_lshlrev_b32 v22, 16, v26
    v_and_b32 v23, 0xffff0000, v26
    v_mul_f32 v22, s35, v22
    v_mul_f32 v23, s35, v23
    v_cvt_pk_bf16_f32 v26, v24, v25
    v_lshlrev_b32 v24, 16, v26
    v_and_b32 v25, 0xffff0000, v26
    v_mul_f32 v24, s34, v24
    v_mul_f32 v25, s34, v25
    v_cvt_pk_bf16_f32 v26, v24, v25
    v_lshlrev_b32 v24, 16, v26
    v_and_b32 v25, 0xffff0000, v26
    v_mul_f32 v24, s35, v24
    v_mul_f32 v25, s35, v25
    v_max3_f32 v26, v18, v19, v20
    v_max3_f32 v26, v26, v21, v22
    v_max3_f32 v26, v26, v23, v24
    v_max3_f32 v26, v26, v25, v8
    v_sub_f32 v27, v8, v26
    v_exp_f32 v27, v27
    v_mov_b32 v8, v26
    v_sub_f32 v18, v18, v26
    v_sub_f32 v19, v19, v26
    v_sub_f32 v20, v20, v26
    v_sub_f32 v21, v21, v26
    v_sub_f32 v22, v22, v26
    v_sub_f32 v23, v23, v26
    v_sub_f32 v24, v24, v26
    v_sub_f32 v25, v25, v26
    v_exp_f32 v18, v18
    v_exp_f32 v19, v19
    v_exp_f32 v20, v20
    v_exp_f32 v21, v21
    v_exp_f32 v22, v22
    v_exp_f32 v23, v23
    v_exp_f32 v24, v24
    v_exp_f32 v25, v25
    v_mul_f32 v9, v9, v27
    v_mul_f32 v10, v10, v27
    v_mul_f32 v11, v11, v27
    v_mul_f32 v12, v12, v27
    v_mul_f32 v13, v13, v27
    v_mul_f32 v14, v14, v27
    v_mul_f32 v15, v15, v27
    v_mul_f32 v16, v16, v27
    v_mul_f32 v17, v17, v27
    v_add_f32 v9, v9, v18
    v_add_f32 v9, v9, v19
    v_add_f32 v9, v9, v20
    v_add_f32 v9, v9, v21
    v_add_f32 v9, v9, v22
    v_add_f32 v9, v9, v23
    v_add_f32 v9, v9, v24
    v_add_f32 v9, v9, v25
    s_add_u32 s31, s31, 32768
    s_mov_b32 s60, s31
    buffer_load_dwordx4 v[128:131], v6, s[12:15], s60 offen offset:0 nt
    buffer_load_dwordx4 v[132:135], v6, s[12:15], s60 offen offset:1024 nt
    buffer_load_dwordx4 v[136:139], v6, s[12:15], s60 offen offset:2048 nt
    buffer_load_dwordx4 v[140:143], v6, s[12:15], s60 offen offset:3072 nt
    buffer_load_dwordx4 v[144:147], v7, s[12:15], s60 offen offset:0 nt
    buffer_load_dwordx4 v[148:151], v7, s[12:15], s60 offen offset:1024 nt
    buffer_load_dwordx4 v[152:155], v7, s[12:15], s60 offen offset:2048 nt
    buffer_load_dwordx4 v[156:159], v7, s[12:15], s60 offen offset:3072 nt
    s_waitcnt vmcnt(24)
    v_lshlrev_b32 v34, 16, v160
    v_and_b32 v35, 0xffff0000, v160
    v_lshlrev_b32 v36, 16, v161
    v_and_b32 v37, 0xffff0000, v161
    v_lshlrev_b32 v38, 16, v162
    v_and_b32 v39, 0xffff0000, v162
    v_lshlrev_b32 v40, 16, v163
    v_and_b32 v41, 0xffff0000, v163
    v_fmac_f32 v10, v34, v18
    v_fmac_f32 v11, v35, v18
    v_fmac_f32 v12, v36, v18
    v_fmac_f32 v13, v37, v18
    v_fmac_f32 v14, v38, v18
    v_fmac_f32 v15, v39, v18
    v_fmac_f32 v16, v40, v18
    v_fmac_f32 v17, v41, v18
    v_lshlrev_b32 v34, 16, v164
    v_and_b32 v35, 0xffff0000, v164
    v_lshlrev_b32 v36, 16, v165
    v_and_b32 v37, 0xffff0000, v165
    v_lshlrev_b32 v38, 16, v166
    v_and_b32 v39, 0xffff0000, v166
    v_lshlrev_b32 v40, 16, v167
    v_and_b32 v41, 0xffff0000, v167
    v_fmac_f32 v10, v34, v19
    v_fmac_f32 v11, v35, v19
    v_fmac_f32 v12, v36, v19
    v_fmac_f32 v13, v37, v19
    v_fmac_f32 v14, v38, v19
    v_fmac_f32 v15, v39, v19
    v_fmac_f32 v16, v40, v19
    v_fmac_f32 v17, v41, v19
    v_lshlrev_b32 v34, 16, v168
    v_and_b32 v35, 0xffff0000, v168
    v_lshlrev_b32 v36, 16, v169
    v_and_b32 v37, 0xffff0000, v169
    v_lshlrev_b32 v38, 16, v170
    v_and_b32 v39, 0xffff0000, v170
    v_lshlrev_b32 v40, 16, v171
    v_and_b32 v41, 0xffff0000, v171
    v_fmac_f32 v10, v34, v20
    v_fmac_f32 v11, v35, v20
    v_fmac_f32 v12, v36, v20
    v_fmac_f32 v13, v37, v20
    v_fmac_f32 v14, v38, v20
    v_fmac_f32 v15, v39, v20
    v_fmac_f32 v16, v40, v20
    v_fmac_f32 v17, v41, v20
    v_lshlrev_b32 v34, 16, v172
    v_and_b32 v35, 0xffff0000, v172
    v_lshlrev_b32 v36, 16, v173
    v_and_b32 v37, 0xffff0000, v173
    v_lshlrev_b32 v38, 16, v174
    v_and_b32 v39, 0xffff0000, v174
    v_lshlrev_b32 v40, 16, v175
    v_and_b32 v41, 0xffff0000, v175
    v_fmac_f32 v10, v34, v21
    v_fmac_f32 v11, v35, v21
    v_fmac_f32 v12, v36, v21
    v_fmac_f32 v13, v37, v21
    v_fmac_f32 v14, v38, v21
    v_fmac_f32 v15, v39, v21
    v_fmac_f32 v16, v40, v21
    v_fmac_f32 v17, v41, v21
    v_lshlrev_b32 v34, 16, v176
    v_and_b32 v35, 0xffff0000, v176
    v_lshlrev_b32 v36, 16, v177
    v_and_b32 v37, 0xffff0000, v177
    v_lshlrev_b32 v38, 16, v178
    v_and_b32 v39, 0xffff0000, v178
    v_lshlrev_b32 v40, 16, v179
    v_and_b32 v41, 0xffff0000, v179
    v_fmac_f32 v10, v34, v22
    v_fmac_f32 v11, v35, v22
    v_fmac_f32 v12, v36, v22
    v_fmac_f32 v13, v37, v22
    v_fmac_f32 v14, v38, v22
    v_fmac_f32 v15, v39, v22
    v_fmac_f32 v16, v40, v22
    v_fmac_f32 v17, v41, v22
    v_lshlrev_b32 v34, 16, v180
    v_and_b32 v35, 0xffff0000, v180
    v_lshlrev_b32 v36, 16, v181
    v_and_b32 v37, 0xffff0000, v181
    v_lshlrev_b32 v38, 16, v182
    v_and_b32 v39, 0xffff0000, v182
    v_lshlrev_b32 v40, 16, v183
    v_and_b32 v41, 0xffff0000, v183
    v_fmac_f32 v10, v34, v23
    v_fmac_f32 v11, v35, v23
    v_fmac_f32 v12, v36, v23
    v_fmac_f32 v13, v37, v23
    v_fmac_f32 v14, v38, v23
    v_fmac_f32 v15, v39, v23
    v_fmac_f32 v16, v40, v23
    v_fmac_f32 v17, v41, v23
    v_lshlrev_b32 v34, 16, v184
    v_and_b32 v35, 0xffff0000, v184
    v_lshlrev_b32 v36, 16, v185
    v_and_b32 v37, 0xffff0000, v185
    v_lshlrev_b32 v38, 16, v186
    v_and_b32 v39, 0xffff0000, v186
    v_lshlrev_b32 v40, 16, v187
    v_and_b32 v41, 0xffff0000, v187
    v_fmac_f32 v10, v34, v24
    v_fmac_f32 v11, v35, v24
    v_fmac_f32 v12, v36, v24
    v_fmac_f32 v13, v37, v24
    v_fmac_f32 v14, v38, v24
    v_fmac_f32 v15, v39, v24
    v_fmac_f32 v16, v40, v24
    v_fmac_f32 v17, v41, v24
    v_lshlrev_b32 v34, 16, v188
    v_and_b32 v35, 0xffff0000, v188
    v_lshlrev_b32 v36, 16, v189
    v_and_b32 v37, 0xffff0000, v189
    v_lshlrev_b32 v38, 16, v190
    v_and_b32 v39, 0xffff0000, v190
    v_lshlrev_b32 v40, 16, v191
    v_and_b32 v41, 0xffff0000, v191
    v_fmac_f32 v10, v34, v25
    v_fmac_f32 v11, v35, v25
    v_fmac_f32 v12, v36, v25
    v_fmac_f32 v13, v37, v25
    v_fmac_f32 v14, v38, v25
    v_fmac_f32 v15, v39, v25
    v_fmac_f32 v16, v40, v25
    v_fmac_f32 v17, v41, v25
    buffer_load_dwordx4 v[160:163], v6, s[16:19], s60 offen offset:0 nt
    buffer_load_dwordx4 v[164:167], v6, s[16:19], s60 offen offset:1024 nt
    buffer_load_dwordx4 v[168:171], v6, s[16:19], s60 offen offset:2048 nt
    buffer_load_dwordx4 v[172:175], v6, s[16:19], s60 offen offset:3072 nt
    buffer_load_dwordx4 v[176:179], v7, s[16:19], s60 offen offset:0 nt
    buffer_load_dwordx4 v[180:183], v7, s[16:19], s60 offen offset:1024 nt
    buffer_load_dwordx4 v[184:187], v7, s[16:19], s60 offen offset:2048 nt
    buffer_load_dwordx4 v[188:191], v7, s[16:19], s60 offen offset:3072 nt
    s_waitcnt vmcnt(24)
    v_dot2_f32_bf16 v18, v192, v2, 0
    v_dot2_f32_bf16 v19, v196, v2, 0
    v_dot2_f32_bf16 v20, v200, v2, 0
    v_dot2_f32_bf16 v21, v204, v2, 0
    v_dot2_f32_bf16 v22, v208, v2, 0
    v_dot2_f32_bf16 v23, v212, v2, 0
    v_dot2_f32_bf16 v24, v216, v2, 0
    v_dot2_f32_bf16 v25, v220, v2, 0
    v_dot2_f32_bf16 v18, v193, v3, v18
    v_dot2_f32_bf16 v19, v197, v3, v19
    v_dot2_f32_bf16 v20, v201, v3, v20
    v_dot2_f32_bf16 v21, v205, v3, v21
    v_dot2_f32_bf16 v22, v209, v3, v22
    v_dot2_f32_bf16 v23, v213, v3, v23
    v_dot2_f32_bf16 v24, v217, v3, v24
    v_dot2_f32_bf16 v25, v221, v3, v25
    v_dot2_f32_bf16 v18, v194, v4, v18
    v_dot2_f32_bf16 v19, v198, v4, v19
    v_dot2_f32_bf16 v20, v202, v4, v20
    v_dot2_f32_bf16 v21, v206, v4, v21
    v_dot2_f32_bf16 v22, v210, v4, v22
    v_dot2_f32_bf16 v23, v214, v4, v23
    v_dot2_f32_bf16 v24, v218, v4, v24
    v_dot2_f32_bf16 v25, v222, v4, v25
    v_dot2_f32_bf16 v18, v195, v5, v18
    v_dot2_f32_bf16 v19, v199, v5, v19
    v_dot2_f32_bf16 v20, v203, v5, v20
    v_dot2_f32_bf16 v21, v207, v5, v21
    v_dot2_f32_bf16 v22, v211, v5, v22
    v_dot2_f32_bf16 v23, v215, v5, v23
    v_dot2_f32_bf16 v24, v219, v5, v24
    v_dot2_f32_bf16 v25, v223, v5, v25
    v_add_f32_dpp v18, v18, v18 row_ror:8 row_mask:0xf bank_mask:0xf
    v_add_f32_dpp v19, v19, v19 row_ror:8 row_mask:0xf bank_mask:0xf
    v_add_f32_dpp v20, v20, v20 row_ror:8 row_mask:0xf bank_mask:0xf
    v_add_f32_dpp v21, v21, v21 row_ror:8 row_mask:0xf bank_mask:0xf
    v_add_f32_dpp v22, v22, v22 row_ror:8 row_mask:0xf bank_mask:0xf
    v_add_f32_dpp v23, v23, v23 row_ror:8 row_mask:0xf bank_mask:0xf
    v_add_f32_dpp v24, v24, v24 row_ror:8 row_mask:0xf bank_mask:0xf
    v_add_f32_dpp v25, v25, v25 row_ror:8 row_mask:0xf bank_mask:0xf
    v_add_f32_dpp v18, v18, v18 row_ror:4 row_mask:0xf bank_mask:0xf
    v_add_f32_dpp v19, v19, v19 row_ror:4 row_mask:0xf bank_mask:0xf
    v_add_f32_dpp v20, v20, v20 row_ror:4 row_mask:0xf bank_mask:0xf
    v_add_f32_dpp v21, v21, v21 row_ror:4 row_mask:0xf bank_mask:0xf
    v_add_f32_dpp v22, v22, v22 row_ror:4 row_mask:0xf bank_mask:0xf
    v_add_f32_dpp v23, v23, v23 row_ror:4 row_mask:0xf bank_mask:0xf
    v_add_f32_dpp v24, v24, v24 row_ror:4 row_mask:0xf bank_mask:0xf
    v_add_f32_dpp v25, v25, v25 row_ror:4 row_mask:0xf bank_mask:0xf
    v_add_f32_dpp v18, v18, v18 row_ror:2 row_mask:0xf bank_mask:0xf
    v_add_f32_dpp v19, v19, v19 row_ror:2 row_mask:0xf bank_mask:0xf
    v_add_f32_dpp v20, v20, v20 row_ror:2 row_mask:0xf bank_mask:0xf
    v_add_f32_dpp v21, v21, v21 row_ror:2 row_mask:0xf bank_mask:0xf
    v_add_f32_dpp v22, v22, v22 row_ror:2 row_mask:0xf bank_mask:0xf
    v_add_f32_dpp v23, v23, v23 row_ror:2 row_mask:0xf bank_mask:0xf
    v_add_f32_dpp v24, v24, v24 row_ror:2 row_mask:0xf bank_mask:0xf
    v_add_f32_dpp v25, v25, v25 row_ror:2 row_mask:0xf bank_mask:0xf
    v_add_f32_dpp v18, v18, v18 row_ror:1 row_mask:0xf bank_mask:0xf
    v_add_f32_dpp v19, v19, v19 row_ror:1 row_mask:0xf bank_mask:0xf
    v_add_f32_dpp v20, v20, v20 row_ror:1 row_mask:0xf bank_mask:0xf
    v_add_f32_dpp v21, v21, v21 row_ror:1 row_mask:0xf bank_mask:0xf
    v_add_f32_dpp v22, v22, v22 row_ror:1 row_mask:0xf bank_mask:0xf
    v_add_f32_dpp v23, v23, v23 row_ror:1 row_mask:0xf bank_mask:0xf
    v_add_f32_dpp v24, v24, v24 row_ror:1 row_mask:0xf bank_mask:0xf
    v_add_f32_dpp v25, v25, v25 row_ror:1 row_mask:0xf bank_mask:0xf
    v_cvt_pk_bf16_f32 v26, v18, v19
    v_lshlrev_b32 v18, 16, v26
    v_and_b32 v19, 0xffff0000, v26
    v_mul_f32 v18, s34, v18
    v_mul_f32 v19, s34, v19
    v_cvt_pk_bf16_f32 v26, v18, v19
    v_lshlrev_b32 v18, 16, v26
    v_and_b32 v19, 0xffff0000, v26
    v_mul_f32 v18, s35, v18
    v_mul_f32 v19, s35, v19
    v_cvt_pk_bf16_f32 v26, v20, v21
    v_lshlrev_b32 v20, 16, v26
    v_and_b32 v21, 0xffff0000, v26
    v_mul_f32 v20, s34, v20
    v_mul_f32 v21, s34, v21
    v_cvt_pk_bf16_f32 v26, v20, v21
    v_lshlrev_b32 v20, 16, v26
    v_and_b32 v21, 0xffff0000, v26
    v_mul_f32 v20, s35, v20
    v_mul_f32 v21, s35, v21
    v_cvt_pk_bf16_f32 v26, v22, v23
    v_lshlrev_b32 v22, 16, v26
    v_and_b32 v23, 0xffff0000, v26
    v_mul_f32 v22, s34, v22
    v_mul_f32 v23, s34, v23
    v_cvt_pk_bf16_f32 v26, v22, v23
    v_lshlrev_b32 v22, 16, v26
    v_and_b32 v23, 0xffff0000, v26
    v_mul_f32 v22, s35, v22
    v_mul_f32 v23, s35, v23
    v_cvt_pk_bf16_f32 v26, v24, v25
    v_lshlrev_b32 v24, 16, v26
    v_and_b32 v25, 0xffff0000, v26
    v_mul_f32 v24, s34, v24
    v_mul_f32 v25, s34, v25
    v_cvt_pk_bf16_f32 v26, v24, v25
    v_lshlrev_b32 v24, 16, v26
    v_and_b32 v25, 0xffff0000, v26
    v_mul_f32 v24, s35, v24
    v_mul_f32 v25, s35, v25
    v_max3_f32 v26, v18, v19, v20
    v_max3_f32 v26, v26, v21, v22
    v_max3_f32 v26, v26, v23, v24
    v_max3_f32 v26, v26, v25, v8
    v_sub_f32 v27, v8, v26
    v_exp_f32 v27, v27
    v_mov_b32 v8, v26
    v_sub_f32 v18, v18, v26
    v_sub_f32 v19, v19, v26
    v_sub_f32 v20, v20, v26
    v_sub_f32 v21, v21, v26
    v_sub_f32 v22, v22, v26
    v_sub_f32 v23, v23, v26
    v_sub_f32 v24, v24, v26
    v_sub_f32 v25, v25, v26
    v_exp_f32 v18, v18
    v_exp_f32 v19, v19
    v_exp_f32 v20, v20
    v_exp_f32 v21, v21
    v_exp_f32 v22, v22
    v_exp_f32 v23, v23
    v_exp_f32 v24, v24
    v_exp_f32 v25, v25
    v_mul_f32 v9, v9, v27
    v_mul_f32 v10, v10, v27
    v_mul_f32 v11, v11, v27
    v_mul_f32 v12, v12, v27
    v_mul_f32 v13, v13, v27
    v_mul_f32 v14, v14, v27
    v_mul_f32 v15, v15, v27
    v_mul_f32 v16, v16, v27
    v_mul_f32 v17, v17, v27
    v_add_f32 v9, v9, v18
    v_add_f32 v9, v9, v19
    v_add_f32 v9, v9, v20
    v_add_f32 v9, v9, v21
    v_add_f32 v9, v9, v22
    v_add_f32 v9, v9, v23
    v_add_f32 v9, v9, v24
    v_add_f32 v9, v9, v25
    s_add_u32 s31, s31, 32768
    s_mov_b32 s61, s31
    buffer_load_dwordx4 v[192:195], v6, s[12:15], s61 offen offset:0 nt
    buffer_load_dwordx4 v[196:199], v6, s[12:15], s61 offen offset:1024 nt
    buffer_load_dwordx4 v[200:203], v6, s[12:15], s61 offen offset:2048 nt
    buffer_load_dwordx4 v[204:207], v6, s[12:15], s61 offen offset:3072 nt
    buffer_load_dwordx4 v[208:211], v7, s[12:15], s61 offen offset:0 nt
    buffer_load_dwordx4 v[212:215], v7, s[12:15], s61 offen offset:1024 nt
    buffer_load_dwordx4 v[216:219], v7, s[12:15], s61 offen offset:2048 nt
    buffer_load_dwordx4 v[220:223], v7, s[12:15], s61 offen offset:3072 nt
    s_waitcnt vmcnt(24)
    v_lshlrev_b32 v34, 16, v224
    v_and_b32 v35, 0xffff0000, v224
    v_lshlrev_b32 v36, 16, v225
    v_and_b32 v37, 0xffff0000, v225
    v_lshlrev_b32 v38, 16, v226
    v_and_b32 v39, 0xffff0000, v226
    v_lshlrev_b32 v40, 16, v227
    v_and_b32 v41, 0xffff0000, v227
    v_fmac_f32 v10, v34, v18
    v_fmac_f32 v11, v35, v18
    v_fmac_f32 v12, v36, v18
    v_fmac_f32 v13, v37, v18
    v_fmac_f32 v14, v38, v18
    v_fmac_f32 v15, v39, v18
    v_fmac_f32 v16, v40, v18
    v_fmac_f32 v17, v41, v18
    v_lshlrev_b32 v34, 16, v228
    v_and_b32 v35, 0xffff0000, v228
    v_lshlrev_b32 v36, 16, v229
    v_and_b32 v37, 0xffff0000, v229
    v_lshlrev_b32 v38, 16, v230
    v_and_b32 v39, 0xffff0000, v230
    v_lshlrev_b32 v40, 16, v231
    v_and_b32 v41, 0xffff0000, v231
    v_fmac_f32 v10, v34, v19
    v_fmac_f32 v11, v35, v19
    v_fmac_f32 v12, v36, v19
    v_fmac_f32 v13, v37, v19
    v_fmac_f32 v14, v38, v19
    v_fmac_f32 v15, v39, v19
    v_fmac_f32 v16, v40, v19
    v_fmac_f32 v17, v41, v19
    v_lshlrev_b32 v34, 16, v232
    v_and_b32 v35, 0xffff0000, v232
    v_lshlrev_b32 v36, 16, v233
    v_and_b32 v37, 0xffff0000, v233
    v_lshlrev_b32 v38, 16, v234
    v_and_b32 v39, 0xffff0000, v234
    v_lshlrev_b32 v40, 16, v235
    v_and_b32 v41, 0xffff0000, v235
    v_fmac_f32 v10, v34, v20
    v_fmac_f32 v11, v35, v20
    v_fmac_f32 v12, v36, v20
    v_fmac_f32 v13, v37, v20
    v_fmac_f32 v14, v38, v20
    v_fmac_f32 v15, v39, v20
    v_fmac_f32 v16, v40, v20
    v_fmac_f32 v17, v41, v20
    v_lshlrev_b32 v34, 16, v236
    v_and_b32 v35, 0xffff0000, v236
    v_lshlrev_b32 v36, 16, v237
    v_and_b32 v37, 0xffff0000, v237
    v_lshlrev_b32 v38, 16, v238
    v_and_b32 v39, 0xffff0000, v238
    v_lshlrev_b32 v40, 16, v239
    v_and_b32 v41, 0xffff0000, v239
    v_fmac_f32 v10, v34, v21
    v_fmac_f32 v11, v35, v21
    v_fmac_f32 v12, v36, v21
    v_fmac_f32 v13, v37, v21
    v_fmac_f32 v14, v38, v21
    v_fmac_f32 v15, v39, v21
    v_fmac_f32 v16, v40, v21
    v_fmac_f32 v17, v41, v21
    v_lshlrev_b32 v34, 16, v240
    v_and_b32 v35, 0xffff0000, v240
    v_lshlrev_b32 v36, 16, v241
    v_and_b32 v37, 0xffff0000, v241
    v_lshlrev_b32 v38, 16, v242
    v_and_b32 v39, 0xffff0000, v242
    v_lshlrev_b32 v40, 16, v243
    v_and_b32 v41, 0xffff0000, v243
    v_fmac_f32 v10, v34, v22
    v_fmac_f32 v11, v35, v22
    v_fmac_f32 v12, v36, v22
    v_fmac_f32 v13, v37, v22
    v_fmac_f32 v14, v38, v22
    v_fmac_f32 v15, v39, v22
    v_fmac_f32 v16, v40, v22
    v_fmac_f32 v17, v41, v22
    v_lshlrev_b32 v34, 16, v244
    v_and_b32 v35, 0xffff0000, v244
    v_lshlrev_b32 v36, 16, v245
    v_and_b32 v37, 0xffff0000, v245
    v_lshlrev_b32 v38, 16, v246
    v_and_b32 v39, 0xffff0000, v246
    v_lshlrev_b32 v40, 16, v247
    v_and_b32 v41, 0xffff0000, v247
    v_fmac_f32 v10, v34, v23
    v_fmac_f32 v11, v35, v23
    v_fmac_f32 v12, v36, v23
    v_fmac_f32 v13, v37, v23
    v_fmac_f32 v14, v38, v23
    v_fmac_f32 v15, v39, v23
    v_fmac_f32 v16, v40, v23
    v_fmac_f32 v17, v41, v23
    v_lshlrev_b32 v34, 16, v248
    v_and_b32 v35, 0xffff0000, v248
    v_lshlrev_b32 v36, 16, v249
    v_and_b32 v37, 0xffff0000, v249
    v_lshlrev_b32 v38, 16, v250
    v_and_b32 v39, 0xffff0000, v250
    v_lshlrev_b32 v40, 16, v251
    v_and_b32 v41, 0xffff0000, v251
    v_fmac_f32 v10, v34, v24
    v_fmac_f32 v11, v35, v24
    v_fmac_f32 v12, v36, v24
    v_fmac_f32 v13, v37, v24
    v_fmac_f32 v14, v38, v24
    v_fmac_f32 v15, v39, v24
    v_fmac_f32 v16, v40, v24
    v_fmac_f32 v17, v41, v24
    v_lshlrev_b32 v34, 16, v252
    v_and_b32 v35, 0xffff0000, v252
    v_lshlrev_b32 v36, 16, v253
    v_and_b32 v37, 0xffff0000, v253
    v_lshlrev_b32 v38, 16, v254
    v_and_b32 v39, 0xffff0000, v254
    v_lshlrev_b32 v40, 16, v255
    v_and_b32 v41, 0xffff0000, v255
    v_fmac_f32 v10, v34, v25
    v_fmac_f32 v11, v35, v25
    v_fmac_f32 v12, v36, v25
    v_fmac_f32 v13, v37, v25
    v_fmac_f32 v14, v38, v25
    v_fmac_f32 v15, v39, v25
    v_fmac_f32 v16, v40, v25
    v_fmac_f32 v17, v41, v25
    buffer_load_dwordx4 v[224:227], v6, s[16:19], s61 offen offset:0 nt
    buffer_load_dwordx4 v[228:231], v6, s[16:19], s61 offen offset:1024 nt
    buffer_load_dwordx4 v[232:235], v6, s[16:19], s61 offen offset:2048 nt
    buffer_load_dwordx4 v[236:239], v6, s[16:19], s61 offen offset:3072 nt
    buffer_load_dwordx4 v[240:243], v7, s[16:19], s61 offen offset:0 nt
    buffer_load_dwordx4 v[244:247], v7, s[16:19], s61 offen offset:1024 nt
    buffer_load_dwordx4 v[248:251], v7, s[16:19], s61 offen offset:2048 nt
    buffer_load_dwordx4 v[252:255], v7, s[16:19], s61 offen offset:3072 nt
    s_waitcnt vmcnt(24)
    v_dot2_f32_bf16 v18, v128, v2, 0
    v_dot2_f32_bf16 v19, v132, v2, 0
    v_dot2_f32_bf16 v20, v136, v2, 0
    v_dot2_f32_bf16 v21, v140, v2, 0
    v_dot2_f32_bf16 v22, v144, v2, 0
    v_dot2_f32_bf16 v23, v148, v2, 0
    v_dot2_f32_bf16 v24, v152, v2, 0
    v_dot2_f32_bf16 v25, v156, v2, 0
    v_dot2_f32_bf16 v18, v129, v3, v18
    v_dot2_f32_bf16 v19, v133, v3, v19
    v_dot2_f32_bf16 v20, v137, v3, v20
    v_dot2_f32_bf16 v21, v141, v3, v21
    v_dot2_f32_bf16 v22, v145, v3, v22
    v_dot2_f32_bf16 v23, v149, v3, v23
    v_dot2_f32_bf16 v24, v153, v3, v24
    v_dot2_f32_bf16 v25, v157, v3, v25
    v_dot2_f32_bf16 v18, v130, v4, v18
    v_dot2_f32_bf16 v19, v134, v4, v19
    v_dot2_f32_bf16 v20, v138, v4, v20
    v_dot2_f32_bf16 v21, v142, v4, v21
    v_dot2_f32_bf16 v22, v146, v4, v22
    v_dot2_f32_bf16 v23, v150, v4, v23
    v_dot2_f32_bf16 v24, v154, v4, v24
    v_dot2_f32_bf16 v25, v158, v4, v25
    v_dot2_f32_bf16 v18, v131, v5, v18
    v_dot2_f32_bf16 v19, v135, v5, v19
    v_dot2_f32_bf16 v20, v139, v5, v20
    v_dot2_f32_bf16 v21, v143, v5, v21
    v_dot2_f32_bf16 v22, v147, v5, v22
    v_dot2_f32_bf16 v23, v151, v5, v23
    v_dot2_f32_bf16 v24, v155, v5, v24
    v_dot2_f32_bf16 v25, v159, v5, v25
    v_add_f32_dpp v18, v18, v18 row_ror:8 row_mask:0xf bank_mask:0xf
    v_add_f32_dpp v19, v19, v19 row_ror:8 row_mask:0xf bank_mask:0xf
    v_add_f32_dpp v20, v20, v20 row_ror:8 row_mask:0xf bank_mask:0xf
    v_add_f32_dpp v21, v21, v21 row_ror:8 row_mask:0xf bank_mask:0xf
    v_add_f32_dpp v22, v22, v22 row_ror:8 row_mask:0xf bank_mask:0xf
    v_add_f32_dpp v23, v23, v23 row_ror:8 row_mask:0xf bank_mask:0xf
    v_add_f32_dpp v24, v24, v24 row_ror:8 row_mask:0xf bank_mask:0xf
    v_add_f32_dpp v25, v25, v25 row_ror:8 row_mask:0xf bank_mask:0xf
    v_add_f32_dpp v18, v18, v18 row_ror:4 row_mask:0xf bank_mask:0xf
    v_add_f32_dpp v19, v19, v19 row_ror:4 row_mask:0xf bank_mask:0xf
    v_add_f32_dpp v20, v20, v20 row_ror:4 row_mask:0xf bank_mask:0xf
    v_add_f32_dpp v21, v21, v21 row_ror:4 row_mask:0xf bank_mask:0xf
    v_add_f32_dpp v22, v22, v22 row_ror:4 row_mask:0xf bank_mask:0xf
    v_add_f32_dpp v23, v23, v23 row_ror:4 row_mask:0xf bank_mask:0xf
    v_add_f32_dpp v24, v24, v24 row_ror:4 row_mask:0xf bank_mask:0xf
    v_add_f32_dpp v25, v25, v25 row_ror:4 row_mask:0xf bank_mask:0xf
    v_add_f32_dpp v18, v18, v18 row_ror:2 row_mask:0xf bank_mask:0xf
    v_add_f32_dpp v19, v19, v19 row_ror:2 row_mask:0xf bank_mask:0xf
    v_add_f32_dpp v20, v20, v20 row_ror:2 row_mask:0xf bank_mask:0xf
    v_add_f32_dpp v21, v21, v21 row_ror:2 row_mask:0xf bank_mask:0xf
    v_add_f32_dpp v22, v22, v22 row_ror:2 row_mask:0xf bank_mask:0xf
    v_add_f32_dpp v23, v23, v23 row_ror:2 row_mask:0xf bank_mask:0xf
    v_add_f32_dpp v24, v24, v24 row_ror:2 row_mask:0xf bank_mask:0xf
    v_add_f32_dpp v25, v25, v25 row_ror:2 row_mask:0xf bank_mask:0xf
    v_add_f32_dpp v18, v18, v18 row_ror:1 row_mask:0xf bank_mask:0xf
    v_add_f32_dpp v19, v19, v19 row_ror:1 row_mask:0xf bank_mask:0xf
    v_add_f32_dpp v20, v20, v20 row_ror:1 row_mask:0xf bank_mask:0xf
    v_add_f32_dpp v21, v21, v21 row_ror:1 row_mask:0xf bank_mask:0xf
    v_add_f32_dpp v22, v22, v22 row_ror:1 row_mask:0xf bank_mask:0xf
    v_add_f32_dpp v23, v23, v23 row_ror:1 row_mask:0xf bank_mask:0xf
    v_add_f32_dpp v24, v24, v24 row_ror:1 row_mask:0xf bank_mask:0xf
    v_add_f32_dpp v25, v25, v25 row_ror:1 row_mask:0xf bank_mask:0xf
    v_cvt_pk_bf16_f32 v26, v18, v19
    v_lshlrev_b32 v18, 16, v26
    v_and_b32 v19, 0xffff0000, v26
    v_mul_f32 v18, s34, v18
    v_mul_f32 v19, s34, v19
    v_cvt_pk_bf16_f32 v26, v18, v19
    v_lshlrev_b32 v18, 16, v26
    v_and_b32 v19, 0xffff0000, v26
    v_mul_f32 v18, s35, v18
    v_mul_f32 v19, s35, v19
    v_cvt_pk_bf16_f32 v26, v20, v21
    v_lshlrev_b32 v20, 16, v26
    v_and_b32 v21, 0xffff0000, v26
    v_mul_f32 v20, s34, v20
    v_mul_f32 v21, s34, v21
    v_cvt_pk_bf16_f32 v26, v20, v21
    v_lshlrev_b32 v20, 16, v26
    v_and_b32 v21, 0xffff0000, v26
    v_mul_f32 v20, s35, v20
    v_mul_f32 v21, s35, v21
    v_cvt_pk_bf16_f32 v26, v22, v23
    v_lshlrev_b32 v22, 16, v26
    v_and_b32 v23, 0xffff0000, v26
    v_mul_f32 v22, s34, v22
    v_mul_f32 v23, s34, v23
    v_cvt_pk_bf16_f32 v26, v22, v23
    v_lshlrev_b32 v22, 16, v26
    v_and_b32 v23, 0xffff0000, v26
    v_mul_f32 v22, s35, v22
    v_mul_f32 v23, s35, v23
    v_cvt_pk_bf16_f32 v26, v24, v25
    v_lshlrev_b32 v24, 16, v26
    v_and_b32 v25, 0xffff0000, v26
    v_mul_f32 v24, s34, v24
    v_mul_f32 v25, s34, v25
    v_cvt_pk_bf16_f32 v26, v24, v25
    v_lshlrev_b32 v24, 16, v26
    v_and_b32 v25, 0xffff0000, v26
    v_mul_f32 v24, s35, v24
    v_mul_f32 v25, s35, v25
    v_max3_f32 v26, v18, v19, v20
    v_max3_f32 v26, v26, v21, v22
    v_max3_f32 v26, v26, v23, v24
    v_max3_f32 v26, v26, v25, v8
    v_sub_f32 v27, v8, v26
    v_exp_f32 v27, v27
    v_mov_b32 v8, v26
    v_sub_f32 v18, v18, v26
    v_sub_f32 v19, v19, v26
    v_sub_f32 v20, v20, v26
    v_sub_f32 v21, v21, v26
    v_sub_f32 v22, v22, v26
    v_sub_f32 v23, v23, v26
    v_sub_f32 v24, v24, v26
    v_sub_f32 v25, v25, v26
    v_exp_f32 v18, v18
    v_exp_f32 v19, v19
    v_exp_f32 v20, v20
    v_exp_f32 v21, v21
    v_exp_f32 v22, v22
    v_exp_f32 v23, v23
    v_exp_f32 v24, v24
    v_exp_f32 v25, v25
    v_mul_f32 v9, v9, v27
    v_mul_f32 v10, v10, v27
    v_mul_f32 v11, v11, v27
    v_mul_f32 v12, v12, v27
    v_mul_f32 v13, v13, v27
    v_mul_f32 v14, v14, v27
    v_mul_f32 v15, v15, v27
    v_mul_f32 v16, v16, v27
    v_mul_f32 v17, v17, v27
    v_add_f32 v9, v9, v18
    v_add_f32 v9, v9, v19
    v_add_f32 v9, v9, v20
    v_add_f32 v9, v9, v21
    v_add_f32 v9, v9, v22
    v_add_f32 v9, v9, v23
    v_add_f32 v9, v9, v24
    v_add_f32 v9, v9, v25
    s_add_u32 s31, s31, 32768
    s_mov_b32 s60, s31
    buffer_load_dwordx4 v[128:131], v6, s[12:15], s60 offen offset:0 nt
    buffer_load_dwordx4 v[132:135], v6, s[12:15], s60 offen offset:1024 nt
    buffer_load_dwordx4 v[136:139], v6, s[12:15], s60 offen offset:2048 nt
    buffer_load_dwordx4 v[140:143], v6, s[12:15], s60 offen offset:3072 nt
    buffer_load_dwordx4 v[144:147], v7, s[12:15], s60 offen offset:0 nt
    buffer_load_dwordx4 v[148:151], v7, s[12:15], s60 offen offset:1024 nt
    buffer_load_dwordx4 v[152:155], v7, s[12:15], s60 offen offset:2048 nt
    buffer_load_dwordx4 v[156:159], v7, s[12:15], s60 offen offset:3072 nt
    s_waitcnt vmcnt(24)
    v_lshlrev_b32 v34, 16, v160
    v_and_b32 v35, 0xffff0000, v160
    v_lshlrev_b32 v36, 16, v161
    v_and_b32 v37, 0xffff0000, v161
    v_lshlrev_b32 v38, 16, v162
    v_and_b32 v39, 0xffff0000, v162
    v_lshlrev_b32 v40, 16, v163
    v_and_b32 v41, 0xffff0000, v163
    v_fmac_f32 v10, v34, v18
    v_fmac_f32 v11, v35, v18
    v_fmac_f32 v12, v36, v18
    v_fmac_f32 v13, v37, v18
    v_fmac_f32 v14, v38, v18
    v_fmac_f32 v15, v39, v18
    v_fmac_f32 v16, v40, v18
    v_fmac_f32 v17, v41, v18
    v_lshlrev_b32 v34, 16, v164
    v_and_b32 v35, 0xffff0000, v164
    v_lshlrev_b32 v36, 16, v165
    v_and_b32 v37, 0xffff0000, v165
    v_lshlrev_b32 v38, 16, v166
    v_and_b32 v39, 0xffff0000, v166
    v_lshlrev_b32 v40, 16, v167
    v_and_b32 v41, 0xffff0000, v167
    v_fmac_f32 v10, v34, v19
    v_fmac_f32 v11, v35, v19
    v_fmac_f32 v12, v36, v19
    v_fmac_f32 v13, v37, v19
    v_fmac_f32 v14, v38, v19
    v_fmac_f32 v15, v39, v19
    v_fmac_f32 v16, v40, v19
    v_fmac_f32 v17, v41, v19
    v_lshlrev_b32 v34, 16, v168
    v_and_b32 v35, 0xffff0000, v168
    v_lshlrev_b32 v36, 16, v169
    v_and_b32 v37, 0xffff0000, v169
    v_lshlrev_b32 v38, 16, v170
    v_and_b32 v39, 0xffff0000, v170
    v_lshlrev_b32 v40, 16, v171
    v_and_b32 v41, 0xffff0000, v171
    v_fmac_f32 v10, v34, v20
    v_fmac_f32 v11, v35, v20
    v_fmac_f32 v12, v36, v20
    v_fmac_f32 v13, v37, v20
    v_fmac_f32 v14, v38, v20
    v_fmac_f32 v15, v39, v20
    v_fmac_f32 v16, v40, v20
    v_fmac_f32 v17, v41, v20
    v_lshlrev_b32 v34, 16, v172
    v_and_b32 v35, 0xffff0000, v172
    v_lshlrev_b32 v36, 16, v173
    v_and_b32 v37, 0xffff0000, v173
    v_lshlrev_b32 v38, 16, v174
    v_and_b32 v39, 0xffff0000, v174
    v_lshlrev_b32 v40, 16, v175
    v_and_b32 v41, 0xffff0000, v175
    v_fmac_f32 v10, v34, v21
    v_fmac_f32 v11, v35, v21
    v_fmac_f32 v12, v36, v21
    v_fmac_f32 v13, v37, v21
    v_fmac_f32 v14, v38, v21
    v_fmac_f32 v15, v39, v21
    v_fmac_f32 v16, v40, v21
    v_fmac_f32 v17, v41, v21
    v_lshlrev_b32 v34, 16, v176
    v_and_b32 v35, 0xffff0000, v176
    v_lshlrev_b32 v36, 16, v177
    v_and_b32 v37, 0xffff0000, v177
    v_lshlrev_b32 v38, 16, v178
    v_and_b32 v39, 0xffff0000, v178
    v_lshlrev_b32 v40, 16, v179
    v_and_b32 v41, 0xffff0000, v179
    v_fmac_f32 v10, v34, v22
    v_fmac_f32 v11, v35, v22
    v_fmac_f32 v12, v36, v22
    v_fmac_f32 v13, v37, v22
    v_fmac_f32 v14, v38, v22
    v_fmac_f32 v15, v39, v22
    v_fmac_f32 v16, v40, v22
    v_fmac_f32 v17, v41, v22
    v_lshlrev_b32 v34, 16, v180
    v_and_b32 v35, 0xffff0000, v180
    v_lshlrev_b32 v36, 16, v181
    v_and_b32 v37, 0xffff0000, v181
    v_lshlrev_b32 v38, 16, v182
    v_and_b32 v39, 0xffff0000, v182
    v_lshlrev_b32 v40, 16, v183
    v_and_b32 v41, 0xffff0000, v183
    v_fmac_f32 v10, v34, v23
    v_fmac_f32 v11, v35, v23
    v_fmac_f32 v12, v36, v23
    v_fmac_f32 v13, v37, v23
    v_fmac_f32 v14, v38, v23
    v_fmac_f32 v15, v39, v23
    v_fmac_f32 v16, v40, v23
    v_fmac_f32 v17, v41, v23
    v_lshlrev_b32 v34, 16, v184
    v_and_b32 v35, 0xffff0000, v184
    v_lshlrev_b32 v36, 16, v185
    v_and_b32 v37, 0xffff0000, v185
    v_lshlrev_b32 v38, 16, v186
    v_and_b32 v39, 0xffff0000, v186
    v_lshlrev_b32 v40, 16, v187
    v_and_b32 v41, 0xffff0000, v187
    v_fmac_f32 v10, v34, v24
    v_fmac_f32 v11, v35, v24
    v_fmac_f32 v12, v36, v24
    v_fmac_f32 v13, v37, v24
    v_fmac_f32 v14, v38, v24
    v_fmac_f32 v15, v39, v24
    v_fmac_f32 v16, v40, v24
    v_fmac_f32 v17, v41, v24
    v_lshlrev_b32 v34, 16, v188
    v_and_b32 v35, 0xffff0000, v188
    v_lshlrev_b32 v36, 16, v189
    v_and_b32 v37, 0xffff0000, v189
    v_lshlrev_b32 v38, 16, v190
    v_and_b32 v39, 0xffff0000, v190
    v_lshlrev_b32 v40, 16, v191
    v_and_b32 v41, 0xffff0000, v191
    v_fmac_f32 v10, v34, v25
    v_fmac_f32 v11, v35, v25
    v_fmac_f32 v12, v36, v25
    v_fmac_f32 v13, v37, v25
    v_fmac_f32 v14, v38, v25
    v_fmac_f32 v15, v39, v25
    v_fmac_f32 v16, v40, v25
    v_fmac_f32 v17, v41, v25
    buffer_load_dwordx4 v[160:163], v6, s[16:19], s60 offen offset:0 nt
    buffer_load_dwordx4 v[164:167], v6, s[16:19], s60 offen offset:1024 nt
    buffer_load_dwordx4 v[168:171], v6, s[16:19], s60 offen offset:2048 nt
    buffer_load_dwordx4 v[172:175], v6, s[16:19], s60 offen offset:3072 nt
    buffer_load_dwordx4 v[176:179], v7, s[16:19], s60 offen offset:0 nt
    buffer_load_dwordx4 v[180:183], v7, s[16:19], s60 offen offset:1024 nt
    buffer_load_dwordx4 v[184:187], v7, s[16:19], s60 offen offset:2048 nt
    buffer_load_dwordx4 v[188:191], v7, s[16:19], s60 offen offset:3072 nt
    s_waitcnt vmcnt(24)
    v_dot2_f32_bf16 v18, v192, v2, 0
    v_dot2_f32_bf16 v19, v196, v2, 0
    v_dot2_f32_bf16 v20, v200, v2, 0
    v_dot2_f32_bf16 v21, v204, v2, 0
    v_dot2_f32_bf16 v22, v208, v2, 0
    v_dot2_f32_bf16 v23, v212, v2, 0
    v_dot2_f32_bf16 v24, v216, v2, 0
    v_dot2_f32_bf16 v25, v220, v2, 0
    v_dot2_f32_bf16 v18, v193, v3, v18
    v_dot2_f32_bf16 v19, v197, v3, v19
    v_dot2_f32_bf16 v20, v201, v3, v20
    v_dot2_f32_bf16 v21, v205, v3, v21
    v_dot2_f32_bf16 v22, v209, v3, v22
    v_dot2_f32_bf16 v23, v213, v3, v23
    v_dot2_f32_bf16 v24, v217, v3, v24
    v_dot2_f32_bf16 v25, v221, v3, v25
    v_dot2_f32_bf16 v18, v194, v4, v18
    v_dot2_f32_bf16 v19, v198, v4, v19
    v_dot2_f32_bf16 v20, v202, v4, v20
    v_dot2_f32_bf16 v21, v206, v4, v21
    v_dot2_f32_bf16 v22, v210, v4, v22
    v_dot2_f32_bf16 v23, v214, v4, v23
    v_dot2_f32_bf16 v24, v218, v4, v24
    v_dot2_f32_bf16 v25, v222, v4, v25
    v_dot2_f32_bf16 v18, v195, v5, v18
    v_dot2_f32_bf16 v19, v199, v5, v19
    v_dot2_f32_bf16 v20, v203, v5, v20
    v_dot2_f32_bf16 v21, v207, v5, v21
    v_dot2_f32_bf16 v22, v211, v5, v22
    v_dot2_f32_bf16 v23, v215, v5, v23
    v_dot2_f32_bf16 v24, v219, v5, v24
    v_dot2_f32_bf16 v25, v223, v5, v25
    v_add_f32_dpp v18, v18, v18 row_ror:8 row_mask:0xf bank_mask:0xf
    v_add_f32_dpp v19, v19, v19 row_ror:8 row_mask:0xf bank_mask:0xf
    v_add_f32_dpp v20, v20, v20 row_ror:8 row_mask:0xf bank_mask:0xf
    v_add_f32_dpp v21, v21, v21 row_ror:8 row_mask:0xf bank_mask:0xf
    v_add_f32_dpp v22, v22, v22 row_ror:8 row_mask:0xf bank_mask:0xf
    v_add_f32_dpp v23, v23, v23 row_ror:8 row_mask:0xf bank_mask:0xf
    v_add_f32_dpp v24, v24, v24 row_ror:8 row_mask:0xf bank_mask:0xf
    v_add_f32_dpp v25, v25, v25 row_ror:8 row_mask:0xf bank_mask:0xf
    v_add_f32_dpp v18, v18, v18 row_ror:4 row_mask:0xf bank_mask:0xf
    v_add_f32_dpp v19, v19, v19 row_ror:4 row_mask:0xf bank_mask:0xf
    v_add_f32_dpp v20, v20, v20 row_ror:4 row_mask:0xf bank_mask:0xf
    v_add_f32_dpp v21, v21, v21 row_ror:4 row_mask:0xf bank_mask:0xf
    v_add_f32_dpp v22, v22, v22 row_ror:4 row_mask:0xf bank_mask:0xf
    v_add_f32_dpp v23, v23, v23 row_ror:4 row_mask:0xf bank_mask:0xf
    v_add_f32_dpp v24, v24, v24 row_ror:4 row_mask:0xf bank_mask:0xf
    v_add_f32_dpp v25, v25, v25 row_ror:4 row_mask:0xf bank_mask:0xf
    v_add_f32_dpp v18, v18, v18 row_ror:2 row_mask:0xf bank_mask:0xf
    v_add_f32_dpp v19, v19, v19 row_ror:2 row_mask:0xf bank_mask:0xf
    v_add_f32_dpp v20, v20, v20 row_ror:2 row_mask:0xf bank_mask:0xf
    v_add_f32_dpp v21, v21, v21 row_ror:2 row_mask:0xf bank_mask:0xf
    v_add_f32_dpp v22, v22, v22 row_ror:2 row_mask:0xf bank_mask:0xf
    v_add_f32_dpp v23, v23, v23 row_ror:2 row_mask:0xf bank_mask:0xf
    v_add_f32_dpp v24, v24, v24 row_ror:2 row_mask:0xf bank_mask:0xf
    v_add_f32_dpp v25, v25, v25 row_ror:2 row_mask:0xf bank_mask:0xf
    v_add_f32_dpp v18, v18, v18 row_ror:1 row_mask:0xf bank_mask:0xf
    v_add_f32_dpp v19, v19, v19 row_ror:1 row_mask:0xf bank_mask:0xf
    v_add_f32_dpp v20, v20, v20 row_ror:1 row_mask:0xf bank_mask:0xf
    v_add_f32_dpp v21, v21, v21 row_ror:1 row_mask:0xf bank_mask:0xf
    v_add_f32_dpp v22, v22, v22 row_ror:1 row_mask:0xf bank_mask:0xf
    v_add_f32_dpp v23, v23, v23 row_ror:1 row_mask:0xf bank_mask:0xf
    v_add_f32_dpp v24, v24, v24 row_ror:1 row_mask:0xf bank_mask:0xf
    v_add_f32_dpp v25, v25, v25 row_ror:1 row_mask:0xf bank_mask:0xf
    v_cvt_pk_bf16_f32 v26, v18, v19
    v_lshlrev_b32 v18, 16, v26
    v_and_b32 v19, 0xffff0000, v26
    v_mul_f32 v18, s34, v18
    v_mul_f32 v19, s34, v19
    v_cvt_pk_bf16_f32 v26, v18, v19
    v_lshlrev_b32 v18, 16, v26
    v_and_b32 v19, 0xffff0000, v26
    v_mul_f32 v18, s35, v18
    v_mul_f32 v19, s35, v19
    v_cvt_pk_bf16_f32 v26, v20, v21
    v_lshlrev_b32 v20, 16, v26
    v_and_b32 v21, 0xffff0000, v26
    v_mul_f32 v20, s34, v20
    v_mul_f32 v21, s34, v21
    v_cvt_pk_bf16_f32 v26, v20, v21
    v_lshlrev_b32 v20, 16, v26
    v_and_b32 v21, 0xffff0000, v26
    v_mul_f32 v20, s35, v20
    v_mul_f32 v21, s35, v21
    v_cvt_pk_bf16_f32 v26, v22, v23
    v_lshlrev_b32 v22, 16, v26
    v_and_b32 v23, 0xffff0000, v26
    v_mul_f32 v22, s34, v22
    v_mul_f32 v23, s34, v23
    v_cvt_pk_bf16_f32 v26, v22, v23
    v_lshlrev_b32 v22, 16, v26
    v_and_b32 v23, 0xffff0000, v26
    v_mul_f32 v22, s35, v22
    v_mul_f32 v23, s35, v23
    v_cvt_pk_bf16_f32 v26, v24, v25
    v_lshlrev_b32 v24, 16, v26
    v_and_b32 v25, 0xffff0000, v26
    v_mul_f32 v24, s34, v24
    v_mul_f32 v25, s34, v25
    v_cvt_pk_bf16_f32 v26, v24, v25
    v_lshlrev_b32 v24, 16, v26
    v_and_b32 v25, 0xffff0000, v26
    v_mul_f32 v24, s35, v24
    v_mul_f32 v25, s35, v25
    v_max3_f32 v26, v18, v19, v20
    v_max3_f32 v26, v26, v21, v22
    v_max3_f32 v26, v26, v23, v24
    v_max3_f32 v26, v26, v25, v8
    v_sub_f32 v27, v8, v26
    v_exp_f32 v27, v27
    v_mov_b32 v8, v26
    v_sub_f32 v18, v18, v26
    v_sub_f32 v19, v19, v26
    v_sub_f32 v20, v20, v26
    v_sub_f32 v21, v21, v26
    v_sub_f32 v22, v22, v26
    v_sub_f32 v23, v23, v26
    v_sub_f32 v24, v24, v26
    v_sub_f32 v25, v25, v26
    v_exp_f32 v18, v18
    v_exp_f32 v19, v19
    v_exp_f32 v20, v20
    v_exp_f32 v21, v21
    v_exp_f32 v22, v22
    v_exp_f32 v23, v23
    v_exp_f32 v24, v24
    v_exp_f32 v25, v25
    v_mul_f32 v9, v9, v27
    v_mul_f32 v10, v10, v27
    v_mul_f32 v11, v11, v27
    v_mul_f32 v12, v12, v27
    v_mul_f32 v13, v13, v27
    v_mul_f32 v14, v14, v27
    v_mul_f32 v15, v15, v27
    v_mul_f32 v16, v16, v27
    v_mul_f32 v17, v17, v27
    v_add_f32 v9, v9, v18
    v_add_f32 v9, v9, v19
    v_add_f32 v9, v9, v20
    v_add_f32 v9, v9, v21
    v_add_f32 v9, v9, v22
    v_add_f32 v9, v9, v23
    v_add_f32 v9, v9, v24
    v_add_f32 v9, v9, v25
    s_add_u32 s31, s31, 32768
    s_mov_b32 s61, s31
    buffer_load_dwordx4 v[192:195], v6, s[12:15], s61 offen offset:0 nt
    buffer_load_dwordx4 v[196:199], v6, s[12:15], s61 offen offset:1024 nt
    buffer_load_dwordx4 v[200:203], v6, s[12:15], s61 offen offset:2048 nt
    buffer_load_dwordx4 v[204:207], v6, s[12:15], s61 offen offset:3072 nt
    buffer_load_dwordx4 v[208:211], v7, s[12:15], s61 offen offset:0 nt
    buffer_load_dwordx4 v[212:215], v7, s[12:15], s61 offen offset:1024 nt
    buffer_load_dwordx4 v[216:219], v7, s[12:15], s61 offen offset:2048 nt
    buffer_load_dwordx4 v[220:223], v7, s[12:15], s61 offen offset:3072 nt
    s_waitcnt vmcnt(24)
    v_lshlrev_b32 v34, 16, v224
    v_and_b32 v35, 0xffff0000, v224
    v_lshlrev_b32 v36, 16, v225
    v_and_b32 v37, 0xffff0000, v225
    v_lshlrev_b32 v38, 16, v226
    v_and_b32 v39, 0xffff0000, v226
    v_lshlrev_b32 v40, 16, v227
    v_and_b32 v41, 0xffff0000, v227
    v_fmac_f32 v10, v34, v18
    v_fmac_f32 v11, v35, v18
    v_fmac_f32 v12, v36, v18
    v_fmac_f32 v13, v37, v18
    v_fmac_f32 v14, v38, v18
    v_fmac_f32 v15, v39, v18
    v_fmac_f32 v16, v40, v18
    v_fmac_f32 v17, v41, v18
    v_lshlrev_b32 v34, 16, v228
    v_and_b32 v35, 0xffff0000, v228
    v_lshlrev_b32 v36, 16, v229
    v_and_b32 v37, 0xffff0000, v229
    v_lshlrev_b32 v38, 16, v230
    v_and_b32 v39, 0xffff0000, v230
    v_lshlrev_b32 v40, 16, v231
    v_and_b32 v41, 0xffff0000, v231
    v_fmac_f32 v10, v34, v19
    v_fmac_f32 v11, v35, v19
    v_fmac_f32 v12, v36, v19
    v_fmac_f32 v13, v37, v19
    v_fmac_f32 v14, v38, v19
    v_fmac_f32 v15, v39, v19
    v_fmac_f32 v16, v40, v19
    v_fmac_f32 v17, v41, v19
    v_lshlrev_b32 v34, 16, v232
    v_and_b32 v35, 0xffff0000, v232
    v_lshlrev_b32 v36, 16, v233
    v_and_b32 v37, 0xffff0000, v233
    v_lshlrev_b32 v38, 16, v234
    v_and_b32 v39, 0xffff0000, v234
    v_lshlrev_b32 v40, 16, v235
    v_and_b32 v41, 0xffff0000, v235
    v_fmac_f32 v10, v34, v20
    v_fmac_f32 v11, v35, v20
    v_fmac_f32 v12, v36, v20
    v_fmac_f32 v13, v37, v20
    v_fmac_f32 v14, v38, v20
    v_fmac_f32 v15, v39, v20
    v_fmac_f32 v16, v40, v20
    v_fmac_f32 v17, v41, v20
    v_lshlrev_b32 v34, 16, v236
    v_and_b32 v35, 0xffff0000, v236
    v_lshlrev_b32 v36, 16, v237
    v_and_b32 v37, 0xffff0000, v237
    v_lshlrev_b32 v38, 16, v238
    v_and_b32 v39, 0xffff0000, v238
    v_lshlrev_b32 v40, 16, v239
    v_and_b32 v41, 0xffff0000, v239
    v_fmac_f32 v10, v34, v21
    v_fmac_f32 v11, v35, v21
    v_fmac_f32 v12, v36, v21
    v_fmac_f32 v13, v37, v21
    v_fmac_f32 v14, v38, v21
    v_fmac_f32 v15, v39, v21
    v_fmac_f32 v16, v40, v21
    v_fmac_f32 v17, v41, v21
    v_lshlrev_b32 v34, 16, v240
    v_and_b32 v35, 0xffff0000, v240
    v_lshlrev_b32 v36, 16, v241
    v_and_b32 v37, 0xffff0000, v241
    v_lshlrev_b32 v38, 16, v242
    v_and_b32 v39, 0xffff0000, v242
    v_lshlrev_b32 v40, 16, v243
    v_and_b32 v41, 0xffff0000, v243
    v_fmac_f32 v10, v34, v22
    v_fmac_f32 v11, v35, v22
    v_fmac_f32 v12, v36, v22
    v_fmac_f32 v13, v37, v22
    v_fmac_f32 v14, v38, v22
    v_fmac_f32 v15, v39, v22
    v_fmac_f32 v16, v40, v22
    v_fmac_f32 v17, v41, v22
    v_lshlrev_b32 v34, 16, v244
    v_and_b32 v35, 0xffff0000, v244
    v_lshlrev_b32 v36, 16, v245
    v_and_b32 v37, 0xffff0000, v245
    v_lshlrev_b32 v38, 16, v246
    v_and_b32 v39, 0xffff0000, v246
    v_lshlrev_b32 v40, 16, v247
    v_and_b32 v41, 0xffff0000, v247
    v_fmac_f32 v10, v34, v23
    v_fmac_f32 v11, v35, v23
    v_fmac_f32 v12, v36, v23
    v_fmac_f32 v13, v37, v23
    v_fmac_f32 v14, v38, v23
    v_fmac_f32 v15, v39, v23
    v_fmac_f32 v16, v40, v23
    v_fmac_f32 v17, v41, v23
    v_lshlrev_b32 v34, 16, v248
    v_and_b32 v35, 0xffff0000, v248
    v_lshlrev_b32 v36, 16, v249
    v_and_b32 v37, 0xffff0000, v249
    v_lshlrev_b32 v38, 16, v250
    v_and_b32 v39, 0xffff0000, v250
    v_lshlrev_b32 v40, 16, v251
    v_and_b32 v41, 0xffff0000, v251
    v_fmac_f32 v10, v34, v24
    v_fmac_f32 v11, v35, v24
    v_fmac_f32 v12, v36, v24
    v_fmac_f32 v13, v37, v24
    v_fmac_f32 v14, v38, v24
    v_fmac_f32 v15, v39, v24
    v_fmac_f32 v16, v40, v24
    v_fmac_f32 v17, v41, v24
    v_lshlrev_b32 v34, 16, v252
    v_and_b32 v35, 0xffff0000, v252
    v_lshlrev_b32 v36, 16, v253
    v_and_b32 v37, 0xffff0000, v253
    v_lshlrev_b32 v38, 16, v254
    v_and_b32 v39, 0xffff0000, v254
    v_lshlrev_b32 v40, 16, v255
    v_and_b32 v41, 0xffff0000, v255
    v_fmac_f32 v10, v34, v25
    v_fmac_f32 v11, v35, v25
    v_fmac_f32 v12, v36, v25
    v_fmac_f32 v13, v37, v25
    v_fmac_f32 v14, v38, v25
    v_fmac_f32 v15, v39, v25
    v_fmac_f32 v16, v40, v25
    v_fmac_f32 v17, v41, v25
    buffer_load_dwordx4 v[224:227], v6, s[16:19], s61 offen offset:0 nt
    buffer_load_dwordx4 v[228:231], v6, s[16:19], s61 offen offset:1024 nt
    buffer_load_dwordx4 v[232:235], v6, s[16:19], s61 offen offset:2048 nt
    buffer_load_dwordx4 v[236:239], v6, s[16:19], s61 offen offset:3072 nt
    buffer_load_dwordx4 v[240:243], v7, s[16:19], s61 offen offset:0 nt
    buffer_load_dwordx4 v[244:247], v7, s[16:19], s61 offen offset:1024 nt
    buffer_load_dwordx4 v[248:251], v7, s[16:19], s61 offen offset:2048 nt
    buffer_load_dwordx4 v[252:255], v7, s[16:19], s61 offen offset:3072 nt
    s_waitcnt vmcnt(24)
    v_dot2_f32_bf16 v18, v128, v2, 0
    v_dot2_f32_bf16 v19, v132, v2, 0
    v_dot2_f32_bf16 v20, v136, v2, 0
    v_dot2_f32_bf16 v21, v140, v2, 0
    v_dot2_f32_bf16 v22, v144, v2, 0
    v_dot2_f32_bf16 v23, v148, v2, 0
    v_dot2_f32_bf16 v24, v152, v2, 0
    v_dot2_f32_bf16 v25, v156, v2, 0
    v_dot2_f32_bf16 v18, v129, v3, v18
    v_dot2_f32_bf16 v19, v133, v3, v19
    v_dot2_f32_bf16 v20, v137, v3, v20
    v_dot2_f32_bf16 v21, v141, v3, v21
    v_dot2_f32_bf16 v22, v145, v3, v22
    v_dot2_f32_bf16 v23, v149, v3, v23
    v_dot2_f32_bf16 v24, v153, v3, v24
    v_dot2_f32_bf16 v25, v157, v3, v25
    v_dot2_f32_bf16 v18, v130, v4, v18
    v_dot2_f32_bf16 v19, v134, v4, v19
    v_dot2_f32_bf16 v20, v138, v4, v20
    v_dot2_f32_bf16 v21, v142, v4, v21
    v_dot2_f32_bf16 v22, v146, v4, v22
    v_dot2_f32_bf16 v23, v150, v4, v23
    v_dot2_f32_bf16 v24, v154, v4, v24
    v_dot2_f32_bf16 v25, v158, v4, v25
    v_dot2_f32_bf16 v18, v131, v5, v18
    v_dot2_f32_bf16 v19, v135, v5, v19
    v_dot2_f32_bf16 v20, v139, v5, v20
    v_dot2_f32_bf16 v21, v143, v5, v21
    v_dot2_f32_bf16 v22, v147, v5, v22
    v_dot2_f32_bf16 v23, v151, v5, v23
    v_dot2_f32_bf16 v24, v155, v5, v24
    v_dot2_f32_bf16 v25, v159, v5, v25
    v_add_f32_dpp v18, v18, v18 row_ror:8 row_mask:0xf bank_mask:0xf
    v_add_f32_dpp v19, v19, v19 row_ror:8 row_mask:0xf bank_mask:0xf
    v_add_f32_dpp v20, v20, v20 row_ror:8 row_mask:0xf bank_mask:0xf
    v_add_f32_dpp v21, v21, v21 row_ror:8 row_mask:0xf bank_mask:0xf
    v_add_f32_dpp v22, v22, v22 row_ror:8 row_mask:0xf bank_mask:0xf
    v_add_f32_dpp v23, v23, v23 row_ror:8 row_mask:0xf bank_mask:0xf
    v_add_f32_dpp v24, v24, v24 row_ror:8 row_mask:0xf bank_mask:0xf
    v_add_f32_dpp v25, v25, v25 row_ror:8 row_mask:0xf bank_mask:0xf
    v_add_f32_dpp v18, v18, v18 row_ror:4 row_mask:0xf bank_mask:0xf
    v_add_f32_dpp v19, v19, v19 row_ror:4 row_mask:0xf bank_mask:0xf
    v_add_f32_dpp v20, v20, v20 row_ror:4 row_mask:0xf bank_mask:0xf
    v_add_f32_dpp v21, v21, v21 row_ror:4 row_mask:0xf bank_mask:0xf
    v_add_f32_dpp v22, v22, v22 row_ror:4 row_mask:0xf bank_mask:0xf
    v_add_f32_dpp v23, v23, v23 row_ror:4 row_mask:0xf bank_mask:0xf
    v_add_f32_dpp v24, v24, v24 row_ror:4 row_mask:0xf bank_mask:0xf
    v_add_f32_dpp v25, v25, v25 row_ror:4 row_mask:0xf bank_mask:0xf
    v_add_f32_dpp v18, v18, v18 row_ror:2 row_mask:0xf bank_mask:0xf
    v_add_f32_dpp v19, v19, v19 row_ror:2 row_mask:0xf bank_mask:0xf
    v_add_f32_dpp v20, v20, v20 row_ror:2 row_mask:0xf bank_mask:0xf
    v_add_f32_dpp v21, v21, v21 row_ror:2 row_mask:0xf bank_mask:0xf
    v_add_f32_dpp v22, v22, v22 row_ror:2 row_mask:0xf bank_mask:0xf
    v_add_f32_dpp v23, v23, v23 row_ror:2 row_mask:0xf bank_mask:0xf
    v_add_f32_dpp v24, v24, v24 row_ror:2 row_mask:0xf bank_mask:0xf
    v_add_f32_dpp v25, v25, v25 row_ror:2 row_mask:0xf bank_mask:0xf
    v_add_f32_dpp v18, v18, v18 row_ror:1 row_mask:0xf bank_mask:0xf
    v_add_f32_dpp v19, v19, v19 row_ror:1 row_mask:0xf bank_mask:0xf
    v_add_f32_dpp v20, v20, v20 row_ror:1 row_mask:0xf bank_mask:0xf
    v_add_f32_dpp v21, v21, v21 row_ror:1 row_mask:0xf bank_mask:0xf
    v_add_f32_dpp v22, v22, v22 row_ror:1 row_mask:0xf bank_mask:0xf
    v_add_f32_dpp v23, v23, v23 row_ror:1 row_mask:0xf bank_mask:0xf
    v_add_f32_dpp v24, v24, v24 row_ror:1 row_mask:0xf bank_mask:0xf
    v_add_f32_dpp v25, v25, v25 row_ror:1 row_mask:0xf bank_mask:0xf
    v_cvt_pk_bf16_f32 v26, v18, v19
    v_lshlrev_b32 v18, 16, v26
    v_and_b32 v19, 0xffff0000, v26
    v_mul_f32 v18, s34, v18
    v_mul_f32 v19, s34, v19
    v_cvt_pk_bf16_f32 v26, v18, v19
    v_lshlrev_b32 v18, 16, v26
    v_and_b32 v19, 0xffff0000, v26
    v_mul_f32 v18, s35, v18
    v_mul_f32 v19, s35, v19
    v_cvt_pk_bf16_f32 v26, v20, v21
    v_lshlrev_b32 v20, 16, v26
    v_and_b32 v21, 0xffff0000, v26
    v_mul_f32 v20, s34, v20
    v_mul_f32 v21, s34, v21
    v_cvt_pk_bf16_f32 v26, v20, v21
    v_lshlrev_b32 v20, 16, v26
    v_and_b32 v21, 0xffff0000, v26
    v_mul_f32 v20, s35, v20
    v_mul_f32 v21, s35, v21
    v_cvt_pk_bf16_f32 v26, v22, v23
    v_lshlrev_b32 v22, 16, v26
    v_and_b32 v23, 0xffff0000, v26
    v_mul_f32 v22, s34, v22
    v_mul_f32 v23, s34, v23
    v_cvt_pk_bf16_f32 v26, v22, v23
    v_lshlrev_b32 v22, 16, v26
    v_and_b32 v23, 0xffff0000, v26
    v_mul_f32 v22, s35, v22
    v_mul_f32 v23, s35, v23
    v_cvt_pk_bf16_f32 v26, v24, v25
    v_lshlrev_b32 v24, 16, v26
    v_and_b32 v25, 0xffff0000, v26
    v_mul_f32 v24, s34, v24
    v_mul_f32 v25, s34, v25
    v_cvt_pk_bf16_f32 v26, v24, v25
    v_lshlrev_b32 v24, 16, v26
    v_and_b32 v25, 0xffff0000, v26
    v_mul_f32 v24, s35, v24
    v_mul_f32 v25, s35, v25
    v_max3_f32 v26, v18, v19, v20
    v_max3_f32 v26, v26, v21, v22
    v_max3_f32 v26, v26, v23, v24
    v_max3_f32 v26, v26, v25, v8
    v_sub_f32 v27, v8, v26
    v_exp_f32 v27, v27
    v_mov_b32 v8, v26
    v_sub_f32 v18, v18, v26
    v_sub_f32 v19, v19, v26
    v_sub_f32 v20, v20, v26
    v_sub_f32 v21, v21, v26
    v_sub_f32 v22, v22, v26
    v_sub_f32 v23, v23, v26
    v_sub_f32 v24, v24, v26
    v_sub_f32 v25, v25, v26
    v_exp_f32 v18, v18
    v_exp_f32 v19, v19
    v_exp_f32 v20, v20
    v_exp_f32 v21, v21
    v_exp_f32 v22, v22
    v_exp_f32 v23, v23
    v_exp_f32 v24, v24
    v_exp_f32 v25, v25
    v_mul_f32 v9, v9, v27
    v_mul_f32 v10, v10, v27
    v_mul_f32 v11, v11, v27
    v_mul_f32 v12, v12, v27
    v_mul_f32 v13, v13, v27
    v_mul_f32 v14, v14, v27
    v_mul_f32 v15, v15, v27
    v_mul_f32 v16, v16, v27
    v_mul_f32 v17, v17, v27
    v_add_f32 v9, v9, v18
    v_add_f32 v9, v9, v19
    v_add_f32 v9, v9, v20
    v_add_f32 v9, v9, v21
    v_add_f32 v9, v9, v22
    v_add_f32 v9, v9, v23
    v_add_f32 v9, v9, v24
    v_add_f32 v9, v9, v25
    s_waitcnt vmcnt(16)
    v_lshlrev_b32 v34, 16, v160
    v_and_b32 v35, 0xffff0000, v160
    v_lshlrev_b32 v36, 16, v161
    v_and_b32 v37, 0xffff0000, v161
    v_lshlrev_b32 v38, 16, v162
    v_and_b32 v39, 0xffff0000, v162
    v_lshlrev_b32 v40, 16, v163
    v_and_b32 v41, 0xffff0000, v163
    v_fmac_f32 v10, v34, v18
    v_fmac_f32 v11, v35, v18
    v_fmac_f32 v12, v36, v18
    v_fmac_f32 v13, v37, v18
    v_fmac_f32 v14, v38, v18
    v_fmac_f32 v15, v39, v18
    v_fmac_f32 v16, v40, v18
    v_fmac_f32 v17, v41, v18
    v_lshlrev_b32 v34, 16, v164
    v_and_b32 v35, 0xffff0000, v164
    v_lshlrev_b32 v36, 16, v165
    v_and_b32 v37, 0xffff0000, v165
    v_lshlrev_b32 v38, 16, v166
    v_and_b32 v39, 0xffff0000, v166
    v_lshlrev_b32 v40, 16, v167
    v_and_b32 v41, 0xffff0000, v167
    v_fmac_f32 v10, v34, v19
    v_fmac_f32 v11, v35, v19
    v_fmac_f32 v12, v36, v19
    v_fmac_f32 v13, v37, v19
    v_fmac_f32 v14, v38, v19
    v_fmac_f32 v15, v39, v19
    v_fmac_f32 v16, v40, v19
    v_fmac_f32 v17, v41, v19
    v_lshlrev_b32 v34, 16, v168
    v_and_b32 v35, 0xffff0000, v168
    v_lshlrev_b32 v36, 16, v169
    v_and_b32 v37, 0xffff0000, v169
    v_lshlrev_b32 v38, 16, v170
    v_and_b32 v39, 0xffff0000, v170
    v_lshlrev_b32 v40, 16, v171
    v_and_b32 v41, 0xffff0000, v171
    v_fmac_f32 v10, v34, v20
    v_fmac_f32 v11, v35, v20
    v_fmac_f32 v12, v36, v20
    v_fmac_f32 v13, v37, v20
    v_fmac_f32 v14, v38, v20
    v_fmac_f32 v15, v39, v20
    v_fmac_f32 v16, v40, v20
    v_fmac_f32 v17, v41, v20
    v_lshlrev_b32 v34, 16, v172
    v_and_b32 v35, 0xffff0000, v172
    v_lshlrev_b32 v36, 16, v173
    v_and_b32 v37, 0xffff0000, v173
    v_lshlrev_b32 v38, 16, v174
    v_and_b32 v39, 0xffff0000, v174
    v_lshlrev_b32 v40, 16, v175
    v_and_b32 v41, 0xffff0000, v175
    v_fmac_f32 v10, v34, v21
    v_fmac_f32 v11, v35, v21
    v_fmac_f32 v12, v36, v21
    v_fmac_f32 v13, v37, v21
    v_fmac_f32 v14, v38, v21
    v_fmac_f32 v15, v39, v21
    v_fmac_f32 v16, v40, v21
    v_fmac_f32 v17, v41, v21
    v_lshlrev_b32 v34, 16, v176
    v_and_b32 v35, 0xffff0000, v176
    v_lshlrev_b32 v36, 16, v177
    v_and_b32 v37, 0xffff0000, v177
    v_lshlrev_b32 v38, 16, v178
    v_and_b32 v39, 0xffff0000, v178
    v_lshlrev_b32 v40, 16, v179
    v_and_b32 v41, 0xffff0000, v179
    v_fmac_f32 v10, v34, v22
    v_fmac_f32 v11, v35, v22
    v_fmac_f32 v12, v36, v22
    v_fmac_f32 v13, v37, v22
    v_fmac_f32 v14, v38, v22
    v_fmac_f32 v15, v39, v22
    v_fmac_f32 v16, v40, v22
    v_fmac_f32 v17, v41, v22
    v_lshlrev_b32 v34, 16, v180
    v_and_b32 v35, 0xffff0000, v180
    v_lshlrev_b32 v36, 16, v181
    v_and_b32 v37, 0xffff0000, v181
    v_lshlrev_b32 v38, 16, v182
    v_and_b32 v39, 0xffff0000, v182
    v_lshlrev_b32 v40, 16, v183
    v_and_b32 v41, 0xffff0000, v183
    v_fmac_f32 v10, v34, v23
    v_fmac_f32 v11, v35, v23
    v_fmac_f32 v12, v36, v23
    v_fmac_f32 v13, v37, v23
    v_fmac_f32 v14, v38, v23
    v_fmac_f32 v15, v39, v23
    v_fmac_f32 v16, v40, v23
    v_fmac_f32 v17, v41, v23
    v_lshlrev_b32 v34, 16, v184
    v_and_b32 v35, 0xffff0000, v184
    v_lshlrev_b32 v36, 16, v185
    v_and_b32 v37, 0xffff0000, v185
    v_lshlrev_b32 v38, 16, v186
    v_and_b32 v39, 0xffff0000, v186
    v_lshlrev_b32 v40, 16, v187
    v_and_b32 v41, 0xffff0000, v187
    v_fmac_f32 v10, v34, v24
    v_fmac_f32 v11, v35, v24
    v_fmac_f32 v12, v36, v24
    v_fmac_f32 v13, v37, v24
    v_fmac_f32 v14, v38, v24
    v_fmac_f32 v15, v39, v24
    v_fmac_f32 v16, v40, v24
    v_fmac_f32 v17, v41, v24
    v_lshlrev_b32 v34, 16, v188
    v_and_b32 v35, 0xffff0000, v188
    v_lshlrev_b32 v36, 16, v189
    v_and_b32 v37, 0xffff0000, v189
    v_lshlrev_b32 v38, 16, v190
    v_and_b32 v39, 0xffff0000, v190
    v_lshlrev_b32 v40, 16, v191
    v_and_b32 v41, 0xffff0000, v191
    v_fmac_f32 v10, v34, v25
    v_fmac_f32 v11, v35, v25
    v_fmac_f32 v12, v36, v25
    v_fmac_f32 v13, v37, v25
    v_fmac_f32 v14, v38, v25
    v_fmac_f32 v15, v39, v25
    v_fmac_f32 v16, v40, v25
    v_fmac_f32 v17, v41, v25
    s_waitcnt vmcnt(8)
    v_dot2_f32_bf16 v18, v192, v2, 0
    v_dot2_f32_bf16 v19, v196, v2, 0
    v_dot2_f32_bf16 v20, v200, v2, 0
    v_dot2_f32_bf16 v21, v204, v2, 0
    v_dot2_f32_bf16 v22, v208, v2, 0
    v_dot2_f32_bf16 v23, v212, v2, 0
    v_dot2_f32_bf16 v24, v216, v2, 0
    v_dot2_f32_bf16 v25, v220, v2, 0
    v_dot2_f32_bf16 v18, v193, v3, v18
    v_dot2_f32_bf16 v19, v197, v3, v19
    v_dot2_f32_bf16 v20, v201, v3, v20
    v_dot2_f32_bf16 v21, v205, v3, v21
    v_dot2_f32_bf16 v22, v209, v3, v22
    v_dot2_f32_bf16 v23, v213, v3, v23
    v_dot2_f32_bf16 v24, v217, v3, v24
    v_dot2_f32_bf16 v25, v221, v3, v25
    v_dot2_f32_bf16 v18, v194, v4, v18
    v_dot2_f32_bf16 v19, v198, v4, v19
    v_dot2_f32_bf16 v20, v202, v4, v20
    v_dot2_f32_bf16 v21, v206, v4, v21
    v_dot2_f32_bf16 v22, v210, v4, v22
    v_dot2_f32_bf16 v23, v214, v4, v23
    v_dot2_f32_bf16 v24, v218, v4, v24
    v_dot2_f32_bf16 v25, v222, v4, v25
    v_dot2_f32_bf16 v18, v195, v5, v18
    v_dot2_f32_bf16 v19, v199, v5, v19
    v_dot2_f32_bf16 v20, v203, v5, v20
    v_dot2_f32_bf16 v21, v207, v5, v21
    v_dot2_f32_bf16 v22, v211, v5, v22
    v_dot2_f32_bf16 v23, v215, v5, v23
    v_dot2_f32_bf16 v24, v219, v5, v24
    v_dot2_f32_bf16 v25, v223, v5, v25
    v_add_f32_dpp v18, v18, v18 row_ror:8 row_mask:0xf bank_mask:0xf
    v_add_f32_dpp v19, v19, v19 row_ror:8 row_mask:0xf bank_mask:0xf
    v_add_f32_dpp v20, v20, v20 row_ror:8 row_mask:0xf bank_mask:0xf
    v_add_f32_dpp v21, v21, v21 row_ror:8 row_mask:0xf bank_mask:0xf
    v_add_f32_dpp v22, v22, v22 row_ror:8 row_mask:0xf bank_mask:0xf
    v_add_f32_dpp v23, v23, v23 row_ror:8 row_mask:0xf bank_mask:0xf
    v_add_f32_dpp v24, v24, v24 row_ror:8 row_mask:0xf bank_mask:0xf
    v_add_f32_dpp v25, v25, v25 row_ror:8 row_mask:0xf bank_mask:0xf
    v_add_f32_dpp v18, v18, v18 row_ror:4 row_mask:0xf bank_mask:0xf
    v_add_f32_dpp v19, v19, v19 row_ror:4 row_mask:0xf bank_mask:0xf
    v_add_f32_dpp v20, v20, v20 row_ror:4 row_mask:0xf bank_mask:0xf
    v_add_f32_dpp v21, v21, v21 row_ror:4 row_mask:0xf bank_mask:0xf
    v_add_f32_dpp v22, v22, v22 row_ror:4 row_mask:0xf bank_mask:0xf
    v_add_f32_dpp v23, v23, v23 row_ror:4 row_mask:0xf bank_mask:0xf
    v_add_f32_dpp v24, v24, v24 row_ror:4 row_mask:0xf bank_mask:0xf
    v_add_f32_dpp v25, v25, v25 row_ror:4 row_mask:0xf bank_mask:0xf
    v_add_f32_dpp v18, v18, v18 row_ror:2 row_mask:0xf bank_mask:0xf
    v_add_f32_dpp v19, v19, v19 row_ror:2 row_mask:0xf bank_mask:0xf
    v_add_f32_dpp v20, v20, v20 row_ror:2 row_mask:0xf bank_mask:0xf
    v_add_f32_dpp v21, v21, v21 row_ror:2 row_mask:0xf bank_mask:0xf
    v_add_f32_dpp v22, v22, v22 row_ror:2 row_mask:0xf bank_mask:0xf
    v_add_f32_dpp v23, v23, v23 row_ror:2 row_mask:0xf bank_mask:0xf
    v_add_f32_dpp v24, v24, v24 row_ror:2 row_mask:0xf bank_mask:0xf
    v_add_f32_dpp v25, v25, v25 row_ror:2 row_mask:0xf bank_mask:0xf
    v_add_f32_dpp v18, v18, v18 row_ror:1 row_mask:0xf bank_mask:0xf
    v_add_f32_dpp v19, v19, v19 row_ror:1 row_mask:0xf bank_mask:0xf
    v_add_f32_dpp v20, v20, v20 row_ror:1 row_mask:0xf bank_mask:0xf
    v_add_f32_dpp v21, v21, v21 row_ror:1 row_mask:0xf bank_mask:0xf
    v_add_f32_dpp v22, v22, v22 row_ror:1 row_mask:0xf bank_mask:0xf
    v_add_f32_dpp v23, v23, v23 row_ror:1 row_mask:0xf bank_mask:0xf
    v_add_f32_dpp v24, v24, v24 row_ror:1 row_mask:0xf bank_mask:0xf
    v_add_f32_dpp v25, v25, v25 row_ror:1 row_mask:0xf bank_mask:0xf
    v_cvt_pk_bf16_f32 v26, v18, v19
    v_lshlrev_b32 v18, 16, v26
    v_and_b32 v19, 0xffff0000, v26
    v_mul_f32 v18, s34, v18
    v_mul_f32 v19, s34, v19
    v_cvt_pk_bf16_f32 v26, v18, v19
    v_lshlrev_b32 v18, 16, v26
    v_and_b32 v19, 0xffff0000, v26
    v_mul_f32 v18, s35, v18
    v_mul_f32 v19, s35, v19
    v_cvt_pk_bf16_f32 v26, v20, v21
    v_lshlrev_b32 v20, 16, v26
    v_and_b32 v21, 0xffff0000, v26
    v_mul_f32 v20, s34, v20
    v_mul_f32 v21, s34, v21
    v_cvt_pk_bf16_f32 v26, v20, v21
    v_lshlrev_b32 v20, 16, v26
    v_and_b32 v21, 0xffff0000, v26
    v_mul_f32 v20, s35, v20
    v_mul_f32 v21, s35, v21
    v_cvt_pk_bf16_f32 v26, v22, v23
    v_lshlrev_b32 v22, 16, v26
    v_and_b32 v23, 0xffff0000, v26
    v_mul_f32 v22, s34, v22
    v_mul_f32 v23, s34, v23
    v_cvt_pk_bf16_f32 v26, v22, v23
    v_lshlrev_b32 v22, 16, v26
    v_and_b32 v23, 0xffff0000, v26
    v_mul_f32 v22, s35, v22
    v_mul_f32 v23, s35, v23
    v_cvt_pk_bf16_f32 v26, v24, v25
    v_lshlrev_b32 v24, 16, v26
    v_and_b32 v25, 0xffff0000, v26
    v_mul_f32 v24, s34, v24
    v_mul_f32 v25, s34, v25
    v_cvt_pk_bf16_f32 v26, v24, v25
    v_lshlrev_b32 v24, 16, v26
    v_and_b32 v25, 0xffff0000, v26
    v_mul_f32 v24, s35, v24
    v_mul_f32 v25, s35, v25
    v_max3_f32 v26, v18, v19, v20
    v_max3_f32 v26, v26, v21, v22
    v_max3_f32 v26, v26, v23, v24
    v_max3_f32 v26, v26, v25, v8
    v_sub_f32 v27, v8, v26
    v_exp_f32 v27, v27
    v_mov_b32 v8, v26
    v_sub_f32 v18, v18, v26
    v_sub_f32 v19, v19, v26
    v_sub_f32 v20, v20, v26
    v_sub_f32 v21, v21, v26
    v_sub_f32 v22, v22, v26
    v_sub_f32 v23, v23, v26
    v_sub_f32 v24, v24, v26
    v_sub_f32 v25, v25, v26
    v_exp_f32 v18, v18
    v_exp_f32 v19, v19
    v_exp_f32 v20, v20
    v_exp_f32 v21, v21
    v_exp_f32 v22, v22
    v_exp_f32 v23, v23
    v_exp_f32 v24, v24
    v_exp_f32 v25, v25
    v_mul_f32 v9, v9, v27
    v_mul_f32 v10, v10, v27
    v_mul_f32 v11, v11, v27
    v_mul_f32 v12, v12, v27
    v_mul_f32 v13, v13, v27
    v_mul_f32 v14, v14, v27
    v_mul_f32 v15, v15, v27
    v_mul_f32 v16, v16, v27
    v_mul_f32 v17, v17, v27
    v_add_f32 v9, v9, v18
    v_add_f32 v9, v9, v19
    v_add_f32 v9, v9, v20
    v_add_f32 v9, v9, v21
    v_add_f32 v9, v9, v22
    v_add_f32 v9, v9, v23
    v_add_f32 v9, v9, v24
    v_add_f32 v9, v9, v25
    s_waitcnt vmcnt(0)
    v_lshlrev_b32 v34, 16, v224
    v_and_b32 v35, 0xffff0000, v224
    v_lshlrev_b32 v36, 16, v225
    v_and_b32 v37, 0xffff0000, v225
    v_lshlrev_b32 v38, 16, v226
    v_and_b32 v39, 0xffff0000, v226
    v_lshlrev_b32 v40, 16, v227
    v_and_b32 v41, 0xffff0000, v227
    v_fmac_f32 v10, v34, v18
    v_fmac_f32 v11, v35, v18
    v_fmac_f32 v12, v36, v18
    v_fmac_f32 v13, v37, v18
    v_fmac_f32 v14, v38, v18
    v_fmac_f32 v15, v39, v18
    v_fmac_f32 v16, v40, v18
    v_fmac_f32 v17, v41, v18
    v_lshlrev_b32 v34, 16, v228
    v_and_b32 v35, 0xffff0000, v228
    v_lshlrev_b32 v36, 16, v229
    v_and_b32 v37, 0xffff0000, v229
    v_lshlrev_b32 v38, 16, v230
    v_and_b32 v39, 0xffff0000, v230
    v_lshlrev_b32 v40, 16, v231
    v_and_b32 v41, 0xffff0000, v231
    v_fmac_f32 v10, v34, v19
    v_fmac_f32 v11, v35, v19
    v_fmac_f32 v12, v36, v19
    v_fmac_f32 v13, v37, v19
    v_fmac_f32 v14, v38, v19
    v_fmac_f32 v15, v39, v19
    v_fmac_f32 v16, v40, v19
    v_fmac_f32 v17, v41, v19
    v_lshlrev_b32 v34, 16, v232
    v_and_b32 v35, 0xffff0000, v232
    v_lshlrev_b32 v36, 16, v233
    v_and_b32 v37, 0xffff0000, v233
    v_lshlrev_b32 v38, 16, v234
    v_and_b32 v39, 0xffff0000, v234
    v_lshlrev_b32 v40, 16, v235
    v_and_b32 v41, 0xffff0000, v235
    v_fmac_f32 v10, v34, v20
    v_fmac_f32 v11, v35, v20
    v_fmac_f32 v12, v36, v20
    v_fmac_f32 v13, v37, v20
    v_fmac_f32 v14, v38, v20
    v_fmac_f32 v15, v39, v20
    v_fmac_f32 v16, v40, v20
    v_fmac_f32 v17, v41, v20
    v_lshlrev_b32 v34, 16, v236
    v_and_b32 v35, 0xffff0000, v236
    v_lshlrev_b32 v36, 16, v237
    v_and_b32 v37, 0xffff0000, v237
    v_lshlrev_b32 v38, 16, v238
    v_and_b32 v39, 0xffff0000, v238
    v_lshlrev_b32 v40, 16, v239
    v_and_b32 v41, 0xffff0000, v239
    v_fmac_f32 v10, v34, v21
    v_fmac_f32 v11, v35, v21
    v_fmac_f32 v12, v36, v21
    v_fmac_f32 v13, v37, v21
    v_fmac_f32 v14, v38, v21
    v_fmac_f32 v15, v39, v21
    v_fmac_f32 v16, v40, v21
    v_fmac_f32 v17, v41, v21
    v_lshlrev_b32 v34, 16, v240
    v_and_b32 v35, 0xffff0000, v240
    v_lshlrev_b32 v36, 16, v241
    v_and_b32 v37, 0xffff0000, v241
    v_lshlrev_b32 v38, 16, v242
    v_and_b32 v39, 0xffff0000, v242
    v_lshlrev_b32 v40, 16, v243
    v_and_b32 v41, 0xffff0000, v243
    v_fmac_f32 v10, v34, v22
    v_fmac_f32 v11, v35, v22
    v_fmac_f32 v12, v36, v22
    v_fmac_f32 v13, v37, v22
    v_fmac_f32 v14, v38, v22
    v_fmac_f32 v15, v39, v22
    v_fmac_f32 v16, v40, v22
    v_fmac_f32 v17, v41, v22
    v_lshlrev_b32 v34, 16, v244
    v_and_b32 v35, 0xffff0000, v244
    v_lshlrev_b32 v36, 16, v245
    v_and_b32 v37, 0xffff0000, v245
    v_lshlrev_b32 v38, 16, v246
    v_and_b32 v39, 0xffff0000, v246
    v_lshlrev_b32 v40, 16, v247
    v_and_b32 v41, 0xffff0000, v247
    v_fmac_f32 v10, v34, v23
    v_fmac_f32 v11, v35, v23
    v_fmac_f32 v12, v36, v23
    v_fmac_f32 v13, v37, v23
    v_fmac_f32 v14, v38, v23
    v_fmac_f32 v15, v39, v23
    v_fmac_f32 v16, v40, v23
    v_fmac_f32 v17, v41, v23
    v_lshlrev_b32 v34, 16, v248
    v_and_b32 v35, 0xffff0000, v248
    v_lshlrev_b32 v36, 16, v249
    v_and_b32 v37, 0xffff0000, v249
    v_lshlrev_b32 v38, 16, v250
    v_and_b32 v39, 0xffff0000, v250
    v_lshlrev_b32 v40, 16, v251
    v_and_b32 v41, 0xffff0000, v251
    v_fmac_f32 v10, v34, v24
    v_fmac_f32 v11, v35, v24
    v_fmac_f32 v12, v36, v24
    v_fmac_f32 v13, v37, v24
    v_fmac_f32 v14, v38, v24
    v_fmac_f32 v15, v39, v24
    v_fmac_f32 v16, v40, v24
    v_fmac_f32 v17, v41, v24
    v_lshlrev_b32 v34, 16, v252
    v_and_b32 v35, 0xffff0000, v252
    v_lshlrev_b32 v36, 16, v253
    v_and_b32 v37, 0xffff0000, v253
    v_lshlrev_b32 v38, 16, v254
    v_and_b32 v39, 0xffff0000, v254
    v_lshlrev_b32 v40, 16, v255
    v_and_b32 v41, 0xffff0000, v255
    v_fmac_f32 v10, v34, v25
    v_fmac_f32 v11, v35, v25
    v_fmac_f32 v12, v36, v25
    v_fmac_f32 v13, v37, v25
    v_fmac_f32 v14, v38, v25
    v_fmac_f32 v15, v39, v25
    v_fmac_f32 v16, v40, v25
    v_fmac_f32 v17, v41, v25
KM_BFIN:
    v_lshrrev_b32 v18, 4, v1
    s_lshl_b32 s27, s26, 2
    v_add_u32 v18, s27, v18
    v_and_b32 v19, 15, v1
    v_lshlrev_b32 v20, 9, v18
    v_lshl_add_u32 v20, v19, 5, v20
    v_add_u32 v20, 140288, v20
    ds_write_b128 v20, v[10:13]
    ds_write_b128 v20, v[14:17] offset:16
    v_lshlrev_b32 v21, 3, v18
    v_add_u32 v21, 148480, v21
    ds_write_b64 v21, v[8:9]
    s_waitcnt lgkmcnt(0)
    s_barrier
    s_cmp_ge_u32 s26, 2
    s_cbranch_scc1 KM_BDONE
    v_mov_b32 v21, 148480
    ds_read_b64 v[64:65], v21 offset:0
    ds_read_b64 v[66:67], v21 offset:8
    ds_read_b64 v[68:69], v21 offset:16
    ds_read_b64 v[70:71], v21 offset:24
    ds_read_b64 v[72:73], v21 offset:32
    ds_read_b64 v[74:75], v21 offset:40
    ds_read_b64 v[76:77], v21 offset:48
    ds_read_b64 v[78:79], v21 offset:56
    ds_read_b64 v[80:81], v21 offset:64
    ds_read_b64 v[82:83], v21 offset:72
    ds_read_b64 v[84:85], v21 offset:80
    ds_read_b64 v[86:87], v21 offset:88
    ds_read_b64 v[88:89], v21 offset:96
    ds_read_b64 v[90:91], v21 offset:104
    ds_read_b64 v[92:93], v21 offset:112
    ds_read_b64 v[94:95], v21 offset:120
    v_lshlrev_b32 v20, 2, v0
    v_add_u32 v20, 140288, v20
    ds_read_b32 v96, v20 offset:0
    ds_read_b32 v97, v20 offset:512
    ds_read_b32 v98, v20 offset:1024
    ds_read_b32 v99, v20 offset:1536
    ds_read_b32 v100, v20 offset:2048
    ds_read_b32 v101, v20 offset:2560
    ds_read_b32 v102, v20 offset:3072
    ds_read_b32 v103, v20 offset:3584
    ds_read_b32 v104, v20 offset:4096
    ds_read_b32 v105, v20 offset:4608
    ds_read_b32 v106, v20 offset:5120
    ds_read_b32 v107, v20 offset:5632
    ds_read_b32 v108, v20 offset:6144
    ds_read_b32 v109, v20 offset:6656
    ds_read_b32 v110, v20 offset:7168
    ds_read_b32 v111, v20 offset:7680
    s_waitcnt lgkmcnt(0)
    v_max3_f32 v8, v64, v66, v68
    v_max3_f32 v8, v8, v70, v72
    v_max3_f32 v8, v8, v74, v76
    v_max3_f32 v8, v8, v78, v80
    v_max3_f32 v8, v8, v82, v84
    v_max3_f32 v8, v8, v86, v88
    v_max3_f32 v8, v8, v90, v92
    v_max_f32 v8, v8, v94
    v_sub_f32 v64, v64, v8
    v_sub_f32 v66, v66, v8
    v_sub_f32 v68, v68, v8
    v_sub_f32 v70, v70, v8
    v_sub_f32 v72, v72, v8
    v_sub_f32 v74, v74, v8
    v_sub_f32 v76, v76, v8
    v_sub_f32 v78, v78, v8
    v_sub_f32 v80, v80, v8
    v_sub_f32 v82, v82, v8
    v_sub_f32 v84, v84, v8
    v_sub_f32 v86, v86, v8
    v_sub_f32 v88, v88, v8
    v_sub_f32 v90, v90, v8
    v_sub_f32 v92, v92, v8
    v_sub_f32 v94, v94, v8
    v_exp_f32 v64, v64
    v_exp_f32 v66, v66
    v_exp_f32 v68, v68
    v_exp_f32 v70, v70
    v_exp_f32 v72, v72
    v_exp_f32 v74, v74
    v_exp_f32 v76, v76
    v_exp_f32 v78, v78
    v_exp_f32 v80, v80
    v_exp_f32 v82, v82
    v_exp_f32 v84, v84
    v_exp_f32 v86, v86
    v_exp_f32 v88, v88
    v_exp_f32 v90, v90
    v_exp_f32 v92, v92
    v_exp_f32 v94, v94
    s_nop 0
    v_mul_f32 v9, v64, v65
    v_mul_f32 v10, v64, v96
    v_fmac_f32 v9, v66, v67
    v_fmac_f32 v10, v66, v97
    v_fmac_f32 v9, v68, v69
    v_fmac_f32 v10, v68, v98
    v_fmac_f32 v9, v70, v71
    v_fmac_f32 v10, v70, v99
    v_fmac_f32 v9, v72, v73
    v_fmac_f32 v10, v72, v100
    v_fmac_f32 v9, v74, v75
    v_fmac_f32 v10, v74, v101
    v_fmac_f32 v9, v76, v77
    v_fmac_f32 v10, v76, v102
    v_fmac_f32 v9, v78, v79
    v_fmac_f32 v10, v78, v103
    v_fmac_f32 v9, v80, v81
    v_fmac_f32 v10, v80, v104
    v_fmac_f32 v9, v82, v83
    v_fmac_f32 v10, v82, v105
    v_fmac_f32 v9, v84, v85
    v_fmac_f32 v10, v84, v106
    v_fmac_f32 v9, v86, v87
    v_fmac_f32 v10, v86, v107
    v_fmac_f32 v9, v88, v89
    v_fmac_f32 v10, v88, v108
    v_fmac_f32 v9, v90, v91
    v_fmac_f32 v10, v90, v109
    v_fmac_f32 v9, v92, v93
    v_fmac_f32 v10, v92, v110
    v_fmac_f32 v9, v94, v95
    v_fmac_f32 v10, v94, v111
    s_lshl_b32 s27, s24, 3
    s_add_u32 s27, s27, s25
    s_lshl_b32 s28, s27, 9
    s_add_u32 s28, s28, 262144
    v_lshlrev_b32 v20, 2, v0
    buffer_store_dword v10, v20, s[20:23], s28 offen
    s_lshl_b32 s28, s27, 3
    s_add_u32 s28, s28, 524288
    v_mov_b32 v20, 0
    buffer_store_dwordx2 v[8:9], v20, s[20:23], s28 offen
KM_BDONE:
KM_END:
    s_endpgm
.globl k3_kernel
.p2align 8
.type k3_kernel,@function
k3_kernel:
    s_cmp_ge_u32 s2, 544
    s_cbranch_scc1 K3_END
    s_cmp_ge_u32 s2, 512
    s_cbranch_scc1 K3_RED
    s_load_dwordx2 s[20:21], s[0:1], 104
    v_and_b32 v1, 63, v0
    v_lshrrev_b32 v2, 6, v0
    s_nop 0
    v_readfirstlane_b32 s26, v2
    s_bfe_u32 s52, s2, 0x20006
    s_and_b32 s53, s2, 63
    s_and_b32 s54, s2, 31
    s_bfe_u32 s55, s2, 0x10005
    s_lshr_b32 s56, s2, 8
    s_cmp_lg_u32 s56, 0
    s_cbranch_scc1 K3_LB
    s_load_dwordx2 s[16:17], s[0:1], 40
    s_load_dwordx2 s[12:13], s[0:1], 32
    s_branch K3_LD
K3_LB:
    s_load_dwordx2 s[16:17], s[0:1], 80
K3_LD:
    v_lshrrev_b32 v44, 2, v0
    v_and_b32 v45, 3, v0
    v_lshlrev_b32 v46, 16, v44
    v_lshl_add_u32 v46, v45, 4, v46
    v_lshlrev_b32 v16, 4, v1
    s_waitcnt lgkmcnt(0)
    s_mov_b32 s18, 4194304
    s_mov_b32 s19, 0x20000
    s_mov_b32 s22, 536870912
    s_mov_b32 s23, 0x20000
    s_cmp_lg_u32 s56, 0
    s_cbranch_scc1 K3_B
    s_mov_b32 s14, 4194304
    s_mov_b32 s15, 0x20000
    v_lshlrev_b32 v4, 3, v0
    v_lshlrev_b32 v5, 3, v1
    s_lshl_b32 s28, s53, 9
    s_add_u32 s28, s28, 196608
    buffer_load_dwordx2 v[8:9], v5, s[20:23], s28 offen
    v_and_b32 v12, 127, v0
    v_lshrrev_b32 v13, 7, v0
    v_lshlrev_b32 v12, 3, v12
    v_lshl_add_u32 v12, v13, 20, v12
    s_lshl_b32 s28, s55, 21
    s_lshl_b32 s29, s54, 10
    s_add_u32 s28, s28, s29
    s_add_u32 s28, s28, 1048576
    buffer_load_dwordx2 v[64:65], v12, s[20:23], s28 offen
    s_add_u32 s28, s28, 0x8000
    buffer_load_dwordx2 v[66:67], v12, s[20:23], s28 offen
    s_add_u32 s28, s28, 0x8000
    buffer_load_dwordx2 v[68:69], v12, s[20:23], s28 offen
    s_add_u32 s28, s28, 0x8000
    buffer_load_dwordx2 v[70:71], v12, s[20:23], s28 offen
    s_add_u32 s28, s28, 0x8000
    buffer_load_dwordx2 v[72:73], v12, s[20:23], s28 offen
    s_add_u32 s28, s28, 0x8000
    buffer_load_dwordx2 v[74:75], v12, s[20:23], s28 offen
    s_add_u32 s28, s28, 0x8000
    buffer_load_dwordx2 v[76:77], v12, s[20:23], s28 offen
    s_add_u32 s28, s28, 0x8000
    buffer_load_dwordx2 v[78:79], v12, s[20:23], s28 offen
    s_add_u32 s28, s28, 0x8000
    buffer_load_dwordx2 v[80:81], v12, s[20:23], s28 offen
    s_add_u32 s28, s28, 0x8000
    buffer_load_dwordx2 v[82:83], v12, s[20:23], s28 offen
    s_add_u32 s28, s28, 0x8000
    buffer_load_dwordx2 v[84:85], v12, s[20:23], s28 offen
    s_add_u32 s28, s28, 0x8000
    buffer_load_dwordx2 v[86:87], v12, s[20:23], s28 offen
    s_add_u32 s28, s28, 0x8000
    buffer_load_dwordx2 v[88:89], v12, s[20:23], s28 offen
    s_add_u32 s28, s28, 0x8000
    buffer_load_dwordx2 v[90:91], v12, s[20:23], s28 offen
    s_add_u32 s28, s28, 0x8000
    buffer_load_dwordx2 v[92:93], v12, s[20:23], s28 offen
    s_add_u32 s28, s28, 0x8000
    buffer_load_dwordx2 v[94:95], v12, s[20:23], s28 offen
    s_add_u32 s28, s28, 0x8000
    buffer_load_dwordx2 v[96:97], v12, s[20:23], s28 offen
    s_add_u32 s28, s28, 0x8000
    buffer_load_dwordx2 v[98:99], v12, s[20:23], s28 offen
    s_add_u32 s28, s28, 0x8000
    buffer_load_dwordx2 v[100:101], v12, s[20:23], s28 offen
    s_add_u32 s28, s28, 0x8000
    buffer_load_dwordx2 v[102:103], v12, s[20:23], s28 offen
    s_add_u32 s28, s28, 0x8000
    buffer_load_dwordx2 v[104:105], v12, s[20:23], s28 offen
    s_add_u32 s28, s28, 0x8000
    buffer_load_dwordx2 v[106:107], v12, s[20:23], s28 offen
    s_add_u32 s28, s28, 0x8000
    buffer_load_dwordx2 v[108:109], v12, s[20:23], s28 offen
    s_add_u32 s28, s28, 0x8000
    buffer_load_dwordx2 v[110:111], v12, s[20:23], s28 offen
    s_add_u32 s28, s28, 0x8000
    buffer_load_dwordx2 v[112:113], v12, s[20:23], s28 offen
    s_add_u32 s28, s28, 0x8000
    buffer_load_dwordx2 v[114:115], v12, s[20:23], s28 offen
    s_add_u32 s28, s28, 0x8000
    buffer_load_dwordx2 v[116:117], v12, s[20:23], s28 offen
    s_add_u32 s28, s28, 0x8000
    buffer_load_dwordx2 v[118:119], v12, s[20:23], s28 offen
    s_add_u32 s28, s28, 0x8000
    buffer_load_dwordx2 v[120:121], v12, s[20:23], s28 offen
    s_add_u32 s28, s28, 0x8000
    buffer_load_dwordx2 v[122:123], v12, s[20:23], s28 offen
    s_add_u32 s28, s28, 0x8000
    buffer_load_dwordx2 v[124:125], v12, s[20:23], s28 offen
    s_add_u32 s28, s28, 0x8000
    buffer_load_dwordx2 v[126:127], v12, s[20:23], s28 offen
    s_add_u32 s28, s28, 0x8000
    s_lshl_b32 s28, s54, 8
    s_lshl_b32 s29, s52, 6
    s_add_u32 s28, s28, s29
    buffer_load_dwordx4 v[192:195], v46, s[12:15], s28 offen nt
    s_add_u32 s28, s28, 8192
    buffer_load_dwordx4 v[196:199], v46, s[12:15], s28 offen nt
    s_add_u32 s28, s28, 8192
    buffer_load_dwordx4 v[200:203], v46, s[12:15], s28 offen nt
    s_add_u32 s28, s28, 8192
    buffer_load_dwordx4 v[204:207], v46, s[12:15], s28 offen nt
    s_add_u32 s28, s28, 8192
    buffer_load_dwordx4 v[208:211], v46, s[12:15], s28 offen nt
    s_add_u32 s28, s28, 8192
    buffer_load_dwordx4 v[212:215], v46, s[12:15], s28 offen nt
    s_add_u32 s28, s28, 8192
    buffer_load_dwordx4 v[216:219], v46, s[12:15], s28 offen nt
    s_add_u32 s28, s28, 8192
    buffer_load_dwordx4 v[220:223], v46, s[12:15], s28 offen nt
    s_add_u32 s28, s28, 8192
    s_lshl_b32 s28, s54, 17
    s_lshl_b32 s29, s52, 15
    s_add_u32 s28, s28, s29
    s_lshl_b32 s29, s26, 13
    s_add_u32 s28, s28, s29
    buffer_load_dwordx4 v[224:227], v16, s[16:19], s28 offen offset:0 nt
    buffer_load_dwordx4 v[228:231], v16, s[16:19], s28 offen offset:1024 nt
    buffer_load_dwordx4 v[232:235], v16, s[16:19], s28 offen offset:2048 nt
    buffer_load_dwordx4 v[236:239], v16, s[16:19], s28 offen offset:3072 nt
    s_add_u32 s28, s28, 4096
    buffer_load_dwordx4 v[240:243], v16, s[16:19], s28 offen offset:0 nt
    buffer_load_dwordx4 v[244:247], v16, s[16:19], s28 offen offset:1024 nt
    buffer_load_dwordx4 v[248:251], v16, s[16:19], s28 offen offset:2048 nt
    buffer_load_dwordx4 v[252:255], v16, s[16:19], s28 offen offset:3072 nt
    s_waitcnt vmcnt(48)
    v_mov_b32 v10, v8
    s_nop 1
    v_max_f32_dpp v10, v10, v10 row_ror:8 row_mask:0xf bank_mask:0xf
    s_nop 1
    v_max_f32_dpp v10, v10, v10 row_ror:4 row_mask:0xf bank_mask:0xf
    s_nop 1
    v_max_f32_dpp v10, v10, v10 row_ror:2 row_mask:0xf bank_mask:0xf
    s_nop 1
    v_max_f32_dpp v10, v10, v10 row_ror:1 row_mask:0xf bank_mask:0xf
    v_mov_b32 v11, v10
    s_nop 1
    v_permlane16_swap_b32 v10, v11
    s_nop 1
    v_max_f32 v10, v10, v11
    v_mov_b32 v11, v10
    s_nop 1
    v_permlane32_swap_b32 v10, v11
    s_nop 1
    v_max_f32 v10, v10, v11
    v_sub_f32 v8, v8, v10
    v_exp_f32 v8, v8
    s_nop 0
    v_mul_f32 v10, v8, v9
    s_nop 1
    v_add_f32_dpp v10, v10, v10 row_ror:8 row_mask:0xf bank_mask:0xf
    s_nop 1
    v_add_f32_dpp v10, v10, v10 row_ror:4 row_mask:0xf bank_mask:0xf
    s_nop 1
    v_add_f32_dpp v10, v10, v10 row_ror:2 row_mask:0xf bank_mask:0xf
    s_nop 1
    v_add_f32_dpp v10, v10, v10 row_ror:1 row_mask:0xf bank_mask:0xf
    v_mov_b32 v11, v10
    s_nop 1
    v_permlane16_swap_b32 v10, v11
    s_nop 1
    v_add_f32 v10, v10, v11
    v_mov_b32 v11, v10
    s_nop 1
    v_permlane32_swap_b32 v10, v11
    s_nop 1
    v_add_f32 v10, v10, v11
    v_rcp_f32 v6, v10
    v_mov_b32 v40, 0
    v_mov_b32 v41, 0
    v_mov_b32 v42, 0
    v_mov_b32 v43, 0
    s_lshr_b32 s30, s26, 1
    s_lshl_b32 s30, s30, 5
    s_add_u32 s31, s30, 0
    v_readlane_b32 s60, v8, s31
    s_waitcnt vmcnt(47)
    v_lshlrev_b32 v48, 16, v64
    v_and_b32 v49, 0xffff0000, v64
    v_lshlrev_b32 v50, 16, v65
    v_and_b32 v51, 0xffff0000, v65
    v_fmac_f32 v40, s60, v48
    v_fmac_f32 v41, s60, v49
    v_fmac_f32 v42, s60, v50
    v_fmac_f32 v43, s60, v51
    s_add_u32 s31, s30, 1
    v_readlane_b32 s61, v8, s31
    s_waitcnt vmcnt(46)
    v_lshlrev_b32 v48, 16, v66
    v_and_b32 v49, 0xffff0000, v66
    v_lshlrev_b32 v50, 16, v67
    v_and_b32 v51, 0xffff0000, v67
    v_fmac_f32 v40, s61, v48
    v_fmac_f32 v41, s61, v49
    v_fmac_f32 v42, s61, v50
    v_fmac_f32 v43, s61, v51
    s_add_u32 s31, s30, 2
    v_readlane_b32 s62, v8, s31
    s_waitcnt vmcnt(45)
    v_lshlrev_b32 v48, 16, v68
    v_and_b32 v49, 0xffff0000, v68
    v_lshlrev_b32 v50, 16, v69
    v_and_b32 v51, 0xffff0000, v69
    v_fmac_f32 v40, s62, v48
    v_fmac_f32 v41, s62, v49
    v_fmac_f32 v42, s62, v50
    v_fmac_f32 v43, s62, v51
    s_add_u32 s31, s30, 3
    v_readlane_b32 s63, v8, s31
    s_waitcnt vmcnt(44)
    v_lshlrev_b32 v48, 16, v70
    v_and_b32 v49, 0xffff0000, v70
    v_lshlrev_b32 v50, 16, v71
    v_and_b32 v51, 0xffff0000, v71
    v_fmac_f32 v40, s63, v48
    v_fmac_f32 v41, s63, v49
    v_fmac_f32 v42, s63, v50
    v_fmac_f32 v43, s63, v51
    s_add_u32 s31, s30, 4
    v_readlane_b32 s60, v8, s31
    s_waitcnt vmcnt(43)
    v_lshlrev_b32 v48, 16, v72
    v_and_b32 v49, 0xffff0000, v72
    v_lshlrev_b32 v50, 16, v73
    v_and_b32 v51, 0xffff0000, v73
    v_fmac_f32 v40, s60, v48
    v_fmac_f32 v41, s60, v49
    v_fmac_f32 v42, s60, v50
    v_fmac_f32 v43, s60, v51
    s_add_u32 s31, s30, 5
    v_readlane_b32 s61, v8, s31
    s_waitcnt vmcnt(42)
    v_lshlrev_b32 v48, 16, v74
    v_and_b32 v49, 0xffff0000, v74
    v_lshlrev_b32 v50, 16, v75
    v_and_b32 v51, 0xffff0000, v75
    v_fmac_f32 v40, s61, v48
    v_fmac_f32 v41, s61, v49
    v_fmac_f32 v42, s61, v50
    v_fmac_f32 v43, s61, v51
    s_add_u32 s31, s30, 6
    v_readlane_b32 s62, v8, s31
    s_waitcnt vmcnt(41)
    v_lshlrev_b32 v48, 16, v76
    v_and_b32 v49, 0xffff0000, v76
    v_lshlrev_b32 v50, 16, v77
    v_and_b32 v51, 0xffff0000, v77
    v_fmac_f32 v40, s62, v48
    v_fmac_f32 v41, s62, v49
    v_fmac_f32 v42, s62, v50
    v_fmac_f32 v43, s62, v51
    s_add_u32 s31, s30, 7
    v_readlane_b32 s63, v8, s31
    s_waitcnt vmcnt(40)
    v_lshlrev_b32 v48, 16, v78
    v_and_b32 v49, 0xffff0000, v78
    v_lshlrev_b32 v50, 16, v79
    v_and_b32 v51, 0xffff0000, v79
    v_fmac_f32 v40, s63, v48
    v_fmac_f32 v41, s63, v49
    v_fmac_f32 v42, s63, v50
    v_fmac_f32 v43, s63, v51
    s_add_u32 s31, s30, 8
    v_readlane_b32 s60, v8, s31
    s_waitcnt vmcnt(39)
    v_lshlrev_b32 v48, 16, v80
    v_and_b32 v49, 0xffff0000, v80
    v_lshlrev_b32 v50, 16, v81
    v_and_b32 v51, 0xffff0000, v81
    v_fmac_f32 v40, s60, v48
    v_fmac_f32 v41, s60, v49
    v_fmac_f32 v42, s60, v50
    v_fmac_f32 v43, s60, v51
    s_add_u32 s31, s30, 9
    v_readlane_b32 s61, v8, s31
    s_waitcnt vmcnt(38)
    v_lshlrev_b32 v48, 16, v82
    v_and_b32 v49, 0xffff0000, v82
    v_lshlrev_b32 v50, 16, v83
    v_and_b32 v51, 0xffff0000, v83
    v_fmac_f32 v40, s61, v48
    v_fmac_f32 v41, s61, v49
    v_fmac_f32 v42, s61, v50
    v_fmac_f32 v43, s61, v51
    s_add_u32 s31, s30, 10
    v_readlane_b32 s62, v8, s31
    s_waitcnt vmcnt(37)
    v_lshlrev_b32 v48, 16, v84
    v_and_b32 v49, 0xffff0000, v84
    v_lshlrev_b32 v50, 16, v85
    v_and_b32 v51, 0xffff0000, v85
    v_fmac_f32 v40, s62, v48
    v_fmac_f32 v41, s62, v49
    v_fmac_f32 v42, s62, v50
    v_fmac_f32 v43, s62, v51
    s_add_u32 s31, s30, 11
    v_readlane_b32 s63, v8, s31
    s_waitcnt vmcnt(36)
    v_lshlrev_b32 v48, 16, v86
    v_and_b32 v49, 0xffff0000, v86
    v_lshlrev_b32 v50, 16, v87
    v_and_b32 v51, 0xffff0000, v87
    v_fmac_f32 v40, s63, v48
    v_fmac_f32 v41, s63, v49
    v_fmac_f32 v42, s63, v50
    v_fmac_f32 v43, s63, v51
    s_add_u32 s31, s30, 12
    v_readlane_b32 s60, v8, s31
    s_waitcnt vmcnt(35)
    v_lshlrev_b32 v48, 16, v88
    v_and_b32 v49, 0xffff0000, v88
    v_lshlrev_b32 v50, 16, v89
    v_and_b32 v51, 0xffff0000, v89
    v_fmac_f32 v40, s60, v48
    v_fmac_f32 v41, s60, v49
    v_fmac_f32 v42, s60, v50
    v_fmac_f32 v43, s60, v51
    s_add_u32 s31, s30, 13
    v_readlane_b32 s61, v8, s31
    s_waitcnt vmcnt(34)
    v_lshlrev_b32 v48, 16, v90
    v_and_b32 v49, 0xffff0000, v90
    v_lshlrev_b32 v50, 16, v91
    v_and_b32 v51, 0xffff0000, v91
    v_fmac_f32 v40, s61, v48
    v_fmac_f32 v41, s61, v49
    v_fmac_f32 v42, s61, v50
    v_fmac_f32 v43, s61, v51
    s_add_u32 s31, s30, 14
    v_readlane_b32 s62, v8, s31
    s_waitcnt vmcnt(33)
    v_lshlrev_b32 v48, 16, v92
    v_and_b32 v49, 0xffff0000, v92
    v_lshlrev_b32 v50, 16, v93
    v_and_b32 v51, 0xffff0000, v93
    v_fmac_f32 v40, s62, v48
    v_fmac_f32 v41, s62, v49
    v_fmac_f32 v42, s62, v50
    v_fmac_f32 v43, s62, v51
    s_add_u32 s31, s30, 15
    v_readlane_b32 s63, v8, s31
    s_waitcnt vmcnt(32)
    v_lshlrev_b32 v48, 16, v94
    v_and_b32 v49, 0xffff0000, v94
    v_lshlrev_b32 v50, 16, v95
    v_and_b32 v51, 0xffff0000, v95
    v_fmac_f32 v40, s63, v48
    v_fmac_f32 v41, s63, v49
    v_fmac_f32 v42, s63, v50
    v_fmac_f32 v43, s63, v51
    s_add_u32 s31, s30, 16
    v_readlane_b32 s60, v8, s31
    s_waitcnt vmcnt(31)
    v_lshlrev_b32 v48, 16, v96
    v_and_b32 v49, 0xffff0000, v96
    v_lshlrev_b32 v50, 16, v97
    v_and_b32 v51, 0xffff0000, v97
    v_fmac_f32 v40, s60, v48
    v_fmac_f32 v41, s60, v49
    v_fmac_f32 v42, s60, v50
    v_fmac_f32 v43, s60, v51
    s_add_u32 s31, s30, 17
    v_readlane_b32 s61, v8, s31
    s_waitcnt vmcnt(30)
    v_lshlrev_b32 v48, 16, v98
    v_and_b32 v49, 0xffff0000, v98
    v_lshlrev_b32 v50, 16, v99
    v_and_b32 v51, 0xffff0000, v99
    v_fmac_f32 v40, s61, v48
    v_fmac_f32 v41, s61, v49
    v_fmac_f32 v42, s61, v50
    v_fmac_f32 v43, s61, v51
    s_add_u32 s31, s30, 18
    v_readlane_b32 s62, v8, s31
    s_waitcnt vmcnt(29)
    v_lshlrev_b32 v48, 16, v100
    v_and_b32 v49, 0xffff0000, v100
    v_lshlrev_b32 v50, 16, v101
    v_and_b32 v51, 0xffff0000, v101
    v_fmac_f32 v40, s62, v48
    v_fmac_f32 v41, s62, v49
    v_fmac_f32 v42, s62, v50
    v_fmac_f32 v43, s62, v51
    s_add_u32 s31, s30, 19
    v_readlane_b32 s63, v8, s31
    s_waitcnt vmcnt(28)
    v_lshlrev_b32 v48, 16, v102
    v_and_b32 v49, 0xffff0000, v102
    v_lshlrev_b32 v50, 16, v103
    v_and_b32 v51, 0xffff0000, v103
    v_fmac_f32 v40, s63, v48
    v_fmac_f32 v41, s63, v49
    v_fmac_f32 v42, s63, v50
    v_fmac_f32 v43, s63, v51
    s_add_u32 s31, s30, 20
    v_readlane_b32 s60, v8, s31
    s_waitcnt vmcnt(27)
    v_lshlrev_b32 v48, 16, v104
    v_and_b32 v49, 0xffff0000, v104
    v_lshlrev_b32 v50, 16, v105
    v_and_b32 v51, 0xffff0000, v105
    v_fmac_f32 v40, s60, v48
    v_fmac_f32 v41, s60, v49
    v_fmac_f32 v42, s60, v50
    v_fmac_f32 v43, s60, v51
    s_add_u32 s31, s30, 21
    v_readlane_b32 s61, v8, s31
    s_waitcnt vmcnt(26)
    v_lshlrev_b32 v48, 16, v106
    v_and_b32 v49, 0xffff0000, v106
    v_lshlrev_b32 v50, 16, v107
    v_and_b32 v51, 0xffff0000, v107
    v_fmac_f32 v40, s61, v48
    v_fmac_f32 v41, s61, v49
    v_fmac_f32 v42, s61, v50
    v_fmac_f32 v43, s61, v51
    s_add_u32 s31, s30, 22
    v_readlane_b32 s62, v8, s31
    s_waitcnt vmcnt(25)
    v_lshlrev_b32 v48, 16, v108
    v_and_b32 v49, 0xffff0000, v108
    v_lshlrev_b32 v50, 16, v109
    v_and_b32 v51, 0xffff0000, v109
    v_fmac_f32 v40, s62, v48
    v_fmac_f32 v41, s62, v49
    v_fmac_f32 v42, s62, v50
    v_fmac_f32 v43, s62, v51
    s_add_u32 s31, s30, 23
    v_readlane_b32 s63, v8, s31
    s_waitcnt vmcnt(24)
    v_lshlrev_b32 v48, 16, v110
    v_and_b32 v49, 0xffff0000, v110
    v_lshlrev_b32 v50, 16, v111
    v_and_b32 v51, 0xffff0000, v111
    v_fmac_f32 v40, s63, v48
    v_fmac_f32 v41, s63, v49
    v_fmac_f32 v42, s63, v50
    v_fmac_f32 v43, s63, v51
    s_add_u32 s31, s30, 24
    v_readlane_b32 s60, v8, s31
    s_waitcnt vmcnt(23)
    v_lshlrev_b32 v48, 16, v112
    v_and_b32 v49, 0xffff0000, v112
    v_lshlrev_b32 v50, 16, v113
    v_and_b32 v51, 0xffff0000, v113
    v_fmac_f32 v40, s60, v48
    v_fmac_f32 v41, s60, v49
    v_fmac_f32 v42, s60, v50
    v_fmac_f32 v43, s60, v51
    s_add_u32 s31, s30, 25
    v_readlane_b32 s61, v8, s31
    s_waitcnt vmcnt(22)
    v_lshlrev_b32 v48, 16, v114
    v_and_b32 v49, 0xffff0000, v114
    v_lshlrev_b32 v50, 16, v115
    v_and_b32 v51, 0xffff0000, v115
    v_fmac_f32 v40, s61, v48
    v_fmac_f32 v41, s61, v49
    v_fmac_f32 v42, s61, v50
    v_fmac_f32 v43, s61, v51
    s_add_u32 s31, s30, 26
    v_readlane_b32 s62, v8, s31
    s_waitcnt vmcnt(21)
    v_lshlrev_b32 v48, 16, v116
    v_and_b32 v49, 0xffff0000, v116
    v_lshlrev_b32 v50, 16, v117
    v_and_b32 v51, 0xffff0000, v117
    v_fmac_f32 v40, s62, v48
    v_fmac_f32 v41, s62, v49
    v_fmac_f32 v42, s62, v50
    v_fmac_f32 v43, s62, v51
    s_add_u32 s31, s30, 27
    v_readlane_b32 s63, v8, s31
    s_waitcnt vmcnt(20)
    v_lshlrev_b32 v48, 16, v118
    v_and_b32 v49, 0xffff0000, v118
    v_lshlrev_b32 v50, 16, v119
    v_and_b32 v51, 0xffff0000, v119
    v_fmac_f32 v40, s63, v48
    v_fmac_f32 v41, s63, v49
    v_fmac_f32 v42, s63, v50
    v_fmac_f32 v43, s63, v51
    s_add_u32 s31, s30, 28
    v_readlane_b32 s60, v8, s31
    s_waitcnt vmcnt(19)
    v_lshlrev_b32 v48, 16, v120
    v_and_b32 v49, 0xffff0000, v120
    v_lshlrev_b32 v50, 16, v121
    v_and_b32 v51, 0xffff0000, v121
    v_fmac_f32 v40, s60, v48
    v_fmac_f32 v41, s60, v49
    v_fmac_f32 v42, s60, v50
    v_fmac_f32 v43, s60, v51
    s_add_u32 s31, s30, 29
    v_readlane_b32 s61, v8, s31
    s_waitcnt vmcnt(18)
    v_lshlrev_b32 v48, 16, v122
    v_and_b32 v49, 0xffff0000, v122
    v_lshlrev_b32 v50, 16, v123
    v_and_b32 v51, 0xffff0000, v123
    v_fmac_f32 v40, s61, v48
    v_fmac_f32 v41, s61, v49
    v_fmac_f32 v42, s61, v50
    v_fmac_f32 v43, s61, v51
    s_add_u32 s31, s30, 30
    v_readlane_b32 s62, v8, s31
    s_waitcnt vmcnt(17)
    v_lshlrev_b32 v48, 16, v124
    v_and_b32 v49, 0xffff0000, v124
    v_lshlrev_b32 v50, 16, v125
    v_and_b32 v51, 0xffff0000, v125
    v_fmac_f32 v40, s62, v48
    v_fmac_f32 v41, s62, v49
    v_fmac_f32 v42, s62, v50
    v_fmac_f32 v43, s62, v51
    s_add_u32 s31, s30, 31
    v_readlane_b32 s63, v8, s31
    s_waitcnt vmcnt(16)
    v_lshlrev_b32 v48, 16, v126
    v_and_b32 v49, 0xffff0000, v126
    v_lshlrev_b32 v50, 16, v127
    v_and_b32 v51, 0xffff0000, v127
    v_fmac_f32 v40, s63, v48
    v_fmac_f32 v41, s63, v49
    v_fmac_f32 v42, s63, v50
    v_fmac_f32 v43, s63, v51
    v_mul_f32 v40, v40, v6
    v_mul_f32 v41, v41, v6
    v_mul_f32 v42, v42, v6
    v_mul_f32 v43, v43, v6
    v_lshlrev_b32 v4, 4, v0
    ds_write_b128 v4, v[40:43] offset:10240
    s_waitcnt lgkmcnt(0)
    s_barrier
    v_lshlrev_b32 v5, 5, v44
    ds_read_b128 v[8:11], v5 offset:10240
    ds_read_b128 v[12:15], v5 offset:10256
    ds_read_b128 v[16:19], v5 offset:12288
    ds_read_b128 v[20:23], v5 offset:12304
    v_mov_b32 v24, 0
    v_mov_b32 v25, 0
    v_mov_b32 v26, 0
    v_mov_b32 v27, 0
    v_mov_b32 v28, 0
    v_mov_b32 v29, 0
    v_mov_b32 v30, 0
    v_mov_b32 v31, 0
    s_waitcnt vmcnt(8) lgkmcnt(0)
    v_add_f32 v8, v8, v16
    v_add_f32 v9, v9, v17
    v_add_f32 v10, v10, v18
    v_add_f32 v11, v11, v19
    v_add_f32 v12, v12, v20
    v_add_f32 v13, v13, v21
    v_add_f32 v14, v14, v22
    v_add_f32 v15, v15, v23
    v_lshlrev_b32 v32, 16, v192
    v_and_b32 v33, 0xffff0000, v192
    v_lshlrev_b32 v34, 16, v193
    v_and_b32 v35, 0xffff0000, v193
    v_lshlrev_b32 v36, 16, v194
    v_and_b32 v37, 0xffff0000, v194
    v_lshlrev_b32 v38, 16, v195
    v_and_b32 v39, 0xffff0000, v195
    v_fmac_f32 v24, v32, v8
    v_fmac_f32 v25, v33, v8
    v_fmac_f32 v26, v34, v8
    v_fmac_f32 v27, v35, v8
    v_fmac_f32 v28, v36, v8
    v_fmac_f32 v29, v37, v8
    v_fmac_f32 v30, v38, v8
    v_fmac_f32 v31, v39, v8
    v_lshlrev_b32 v32, 16, v196
    v_and_b32 v33, 0xffff0000, v196
    v_lshlrev_b32 v34, 16, v197
    v_and_b32 v35, 0xffff0000, v197
    v_lshlrev_b32 v36, 16, v198
    v_and_b32 v37, 0xffff0000, v198
    v_lshlrev_b32 v38, 16, v199
    v_and_b32 v39, 0xffff0000, v199
    v_fmac_f32 v24, v32, v9
    v_fmac_f32 v25, v33, v9
    v_fmac_f32 v26, v34, v9
    v_fmac_f32 v27, v35, v9
    v_fmac_f32 v28, v36, v9
    v_fmac_f32 v29, v37, v9
    v_fmac_f32 v30, v38, v9
    v_fmac_f32 v31, v39, v9
    v_lshlrev_b32 v32, 16, v200
    v_and_b32 v33, 0xffff0000, v200
    v_lshlrev_b32 v34, 16, v201
    v_and_b32 v35, 0xffff0000, v201
    v_lshlrev_b32 v36, 16, v202
    v_and_b32 v37, 0xffff0000, v202
    v_lshlrev_b32 v38, 16, v203
    v_and_b32 v39, 0xffff0000, v203
    v_fmac_f32 v24, v32, v10
    v_fmac_f32 v25, v33, v10
    v_fmac_f32 v26, v34, v10
    v_fmac_f32 v27, v35, v10
    v_fmac_f32 v28, v36, v10
    v_fmac_f32 v29, v37, v10
    v_fmac_f32 v30, v38, v10
    v_fmac_f32 v31, v39, v10
    v_lshlrev_b32 v32, 16, v204
    v_and_b32 v33, 0xffff0000, v204
    v_lshlrev_b32 v34, 16, v205
    v_and_b32 v35, 0xffff0000, v205
    v_lshlrev_b32 v36, 16, v206
    v_and_b32 v37, 0xffff0000, v206
    v_lshlrev_b32 v38, 16, v207
    v_and_b32 v39, 0xffff0000, v207
    v_fmac_f32 v24, v32, v11
    v_fmac_f32 v25, v33, v11
    v_fmac_f32 v26, v34, v11
    v_fmac_f32 v27, v35, v11
    v_fmac_f32 v28, v36, v11
    v_fmac_f32 v29, v37, v11
    v_fmac_f32 v30, v38, v11
    v_fmac_f32 v31, v39, v11
    v_lshlrev_b32 v32, 16, v208
    v_and_b32 v33, 0xffff0000, v208
    v_lshlrev_b32 v34, 16, v209
    v_and_b32 v35, 0xffff0000, v209
    v_lshlrev_b32 v36, 16, v210
    v_and_b32 v37, 0xffff0000, v210
    v_lshlrev_b32 v38, 16, v211
    v_and_b32 v39, 0xffff0000, v211
    v_fmac_f32 v24, v32, v12
    v_fmac_f32 v25, v33, v12
    v_fmac_f32 v26, v34, v12
    v_fmac_f32 v27, v35, v12
    v_fmac_f32 v28, v36, v12
    v_fmac_f32 v29, v37, v12
    v_fmac_f32 v30, v38, v12
    v_fmac_f32 v31, v39, v12
    v_lshlrev_b32 v32, 16, v212
    v_and_b32 v33, 0xffff0000, v212
    v_lshlrev_b32 v34, 16, v213
    v_and_b32 v35, 0xffff0000, v213
    v_lshlrev_b32 v36, 16, v214
    v_and_b32 v37, 0xffff0000, v214
    v_lshlrev_b32 v38, 16, v215
    v_and_b32 v39, 0xffff0000, v215
    v_fmac_f32 v24, v32, v13
    v_fmac_f32 v25, v33, v13
    v_fmac_f32 v26, v34, v13
    v_fmac_f32 v27, v35, v13
    v_fmac_f32 v28, v36, v13
    v_fmac_f32 v29, v37, v13
    v_fmac_f32 v30, v38, v13
    v_fmac_f32 v31, v39, v13
    v_lshlrev_b32 v32, 16, v216
    v_and_b32 v33, 0xffff0000, v216
    v_lshlrev_b32 v34, 16, v217
    v_and_b32 v35, 0xffff0000, v217
    v_lshlrev_b32 v36, 16, v218
    v_and_b32 v37, 0xffff0000, v218
    v_lshlrev_b32 v38, 16, v219
    v_and_b32 v39, 0xffff0000, v219
    v_fmac_f32 v24, v32, v14
    v_fmac_f32 v25, v33, v14
    v_fmac_f32 v26, v34, v14
    v_fmac_f32 v27, v35, v14
    v_fmac_f32 v28, v36, v14
    v_fmac_f32 v29, v37, v14
    v_fmac_f32 v30, v38, v14
    v_fmac_f32 v31, v39, v14
    v_lshlrev_b32 v32, 16, v220
    v_and_b32 v33, 0xffff0000, v220
    v_lshlrev_b32 v34, 16, v221
    v_and_b32 v35, 0xffff0000, v221
    v_lshlrev_b32 v36, 16, v222
    v_and_b32 v37, 0xffff0000, v222
    v_lshlrev_b32 v38, 16, v223
    v_and_b32 v39, 0xffff0000, v223
    v_fmac_f32 v24, v32, v15
    v_fmac_f32 v25, v33, v15
    v_fmac_f32 v26, v34, v15
    v_fmac_f32 v27, v35, v15
    v_fmac_f32 v28, v36, v15
    v_fmac_f32 v29, v37, v15
    v_fmac_f32 v30, v38, v15
    v_fmac_f32 v31, v39, v15
    v_lshlrev_b32 v5, 7, v44
    v_lshl_add_u32 v5, v45, 5, v5
    ds_write_b128 v5, v[24:27] offset:2048
    ds_write_b128 v5, v[28:31] offset:2064
    s_waitcnt lgkmcnt(0)
    s_barrier
    v_and_b32 v5, 31, v1
    v_lshrrev_b32 v6, 5, v1
    v_lshlrev_b32 v5, 2, v5
    v_lshl_add_u32 v5, v6, 12, v5
    ds_read_b32 v64, v5 offset:2048
    ds_read_b32 v65, v5 offset:2176
    ds_read_b32 v66, v5 offset:2304
    ds_read_b32 v67, v5 offset:2432
    ds_read_b32 v68, v5 offset:2560
    ds_read_b32 v69, v5 offset:2688
    ds_read_b32 v70, v5 offset:2816
    ds_read_b32 v71, v5 offset:2944
    ds_read_b32 v72, v5 offset:3072
    ds_read_b32 v73, v5 offset:3200
    ds_read_b32 v74, v5 offset:3328
    ds_read_b32 v75, v5 offset:3456
    ds_read_b32 v76, v5 offset:3584
    ds_read_b32 v77, v5 offset:3712
    ds_read_b32 v78, v5 offset:3840
    ds_read_b32 v79, v5 offset:3968
    ds_read_b32 v80, v5 offset:4096
    ds_read_b32 v81, v5 offset:4224
    ds_read_b32 v82, v5 offset:4352
    ds_read_b32 v83, v5 offset:4480
    ds_read_b32 v84, v5 offset:4608
    ds_read_b32 v85, v5 offset:4736
    ds_read_b32 v86, v5 offset:4864
    ds_read_b32 v87, v5 offset:4992
    ds_read_b32 v88, v5 offset:5120
    ds_read_b32 v89, v5 offset:5248
    ds_read_b32 v90, v5 offset:5376
    ds_read_b32 v91, v5 offset:5504
    ds_read_b32 v92, v5 offset:5632
    ds_read_b32 v93, v5 offset:5760
    ds_read_b32 v94, v5 offset:5888
    ds_read_b32 v95, v5 offset:6016
    s_waitcnt lgkmcnt(0)
    v_add_f32 v64, v64, v80
    v_add_f32 v65, v65, v81
    v_add_f32 v66, v66, v82
    v_add_f32 v67, v67, v83
    v_add_f32 v68, v68, v84
    v_add_f32 v69, v69, v85
    v_add_f32 v70, v70, v86
    v_add_f32 v71, v71, v87
    v_add_f32 v72, v72, v88
    v_add_f32 v73, v73, v89
    v_add_f32 v74, v74, v90
    v_add_f32 v75, v75, v91
    v_add_f32 v76, v76, v92
    v_add_f32 v77, v77, v93
    v_add_f32 v78, v78, v94
    v_add_f32 v79, v79, v95
    v_add_f32 v64, v64, v72
    v_add_f32 v65, v65, v73
    v_add_f32 v66, v66, v74
    v_add_f32 v67, v67, v75
    v_add_f32 v68, v68, v76
    v_add_f32 v69, v69, v77
    v_add_f32 v70, v70, v78
    v_add_f32 v71, v71, v79
    v_add_f32 v64, v64, v68
    v_add_f32 v65, v65, v69
    v_add_f32 v66, v66, v70
    v_add_f32 v67, v67, v71
    v_add_f32 v64, v64, v66
    v_add_f32 v65, v65, v67
    v_add_f32 v64, v64, v65
    v_mov_b32 v65, v64
    s_nop 1
    v_permlane32_swap_b32 v64, v65
    s_nop 1
    v_add_f32 v64, v64, v65
    v_cvt_pk_bf16_f32 v64, v64, v64
    v_lshlrev_b32 v64, 16, v64
    s_branch K3_OUT
K3_B:
    v_mov_b32 v5, 0
    s_lshl_b32 s28, s53, 6
    s_add_u32 s28, s28, 524288
    buffer_load_dwordx4 v[8:11], v5, s[20:23], s28 offen offset:0
    buffer_load_dwordx4 v[12:15], v5, s[20:23], s28 offen offset:16
    v_and_b32 v5, 31, v1
    v_lshlrev_b32 v5, 2, v5
    s_lshl_b32 s28, s53, 12
    s_lshl_b32 s29, s52, 7
    s_add_u32 s28, s28, s29
    s_add_u32 s28, s28, 262144
    buffer_load_dword v64, v5, s[20:23], s28 offen offset:0
    buffer_load_dword v65, v5, s[20:23], s28 offen offset:512
    buffer_load_dword v66, v5, s[20:23], s28 offen offset:1024
    buffer_load_dword v67, v5, s[20:23], s28 offen offset:1536
    s_lshl_b32 s28, s54, 17
    s_lshl_b32 s29, s52, 15
    s_add_u32 s28, s28, s29
    s_lshl_b32 s29, s26, 13
    s_add_u32 s28, s28, s29
    buffer_load_dwordx4 v[224:227], v16, s[16:19], s28 offen offset:0 nt
    buffer_load_dwordx4 v[228:231], v16, s[16:19], s28 offen offset:1024 nt
    buffer_load_dwordx4 v[232:235], v16, s[16:19], s28 offen offset:2048 nt
    buffer_load_dwordx4 v[236:239], v16, s[16:19], s28 offen offset:3072 nt
    s_add_u32 s28, s28, 4096
    buffer_load_dwordx4 v[240:243], v16, s[16:19], s28 offen offset:0 nt
    buffer_load_dwordx4 v[244:247], v16, s[16:19], s28 offen offset:1024 nt
    buffer_load_dwordx4 v[248:251], v16, s[16:19], s28 offen offset:2048 nt
    buffer_load_dwordx4 v[252:255], v16, s[16:19], s28 offen offset:3072 nt
    s_waitcnt vmcnt(8)
    v_max3_f32 v56, v8, v10, v12
    v_max_f32 v56, v56, v14
    v_sub_f32 v8, v8, v56
    v_sub_f32 v10, v10, v56
    v_sub_f32 v12, v12, v56
    v_sub_f32 v14, v14, v56
    v_exp_f32 v8, v8
    v_exp_f32 v10, v10
    v_exp_f32 v12, v12
    v_exp_f32 v14, v14
    s_nop 0
    v_mul_f32 v57, v8, v9
    v_mul_f32 v58, v8, v64
    v_fmac_f32 v57, v10, v11
    v_fmac_f32 v58, v10, v65
    v_fmac_f32 v57, v12, v13
    v_fmac_f32 v58, v12, v66
    v_fmac_f32 v57, v14, v15
    v_fmac_f32 v58, v14, v67
    v_rcp_f32 v57, v57
    s_nop 0
    v_mul_f32 v58, v58, v57
    v_cvt_pk_bf16_f32 v58, v58, v58
    v_lshlrev_b32 v64, 16, v58
K3_OUT:
    s_lshl_b32 s30, s26, 3
    v_mov_b32 v24, 0
    v_mov_b32 v25, 0
    v_mov_b32 v26, 0
    v_mov_b32 v27, 0
    v_mov_b32 v28, 0
    v_mov_b32 v29, 0
    v_mov_b32 v30, 0
    v_mov_b32 v31, 0
    s_waitcnt vmcnt(0)
    s_add_u32 s31, s30, 0
    v_readlane_b32 s60, v64, s31
    s_add_u32 s31, s30, 1
    v_readlane_b32 s61, v64, s31
    s_add_u32 s31, s30, 2
    v_readlane_b32 s62, v64, s31
    s_add_u32 s31, s30, 3
    v_readlane_b32 s63, v64, s31
    s_add_u32 s31, s30, 4
    v_readlane_b32 s64, v64, s31
    s_add_u32 s31, s30, 5
    v_readlane_b32 s65, v64, s31
    s_add_u32 s31, s30, 6
    v_readlane_b32 s66, v64, s31
    s_add_u32 s31, s30, 7
    v_readlane_b32 s67, v64, s31
    v_lshlrev_b32 v32, 16, v224
    v_and_b32 v33, 0xffff0000, v224
    v_lshlrev_b32 v34, 16, v225
    v_and_b32 v35, 0xffff0000, v225
    v_lshlrev_b32 v36, 16, v226
    v_and_b32 v37, 0xffff0000, v226
    v_lshlrev_b32 v38, 16, v227
    v_and_b32 v39, 0xffff0000, v227
    v_fmac_f32 v24, s60, v32
    v_fmac_f32 v25, s60, v33
    v_fmac_f32 v26, s60, v34
    v_fmac_f32 v27, s60, v35
    v_fmac_f32 v28, s60, v36
    v_fmac_f32 v29, s60, v37
    v_fmac_f32 v30, s60, v38
    v_fmac_f32 v31, s60, v39
    v_lshlrev_b32 v32, 16, v228
    v_and_b32 v33, 0xffff0000, v228
    v_lshlrev_b32 v34, 16, v229
    v_and_b32 v35, 0xffff0000, v229
    v_lshlrev_b32 v36, 16, v230
    v_and_b32 v37, 0xffff0000, v230
    v_lshlrev_b32 v38, 16, v231
    v_and_b32 v39, 0xffff0000, v231
    v_fmac_f32 v24, s61, v32
    v_fmac_f32 v25, s61, v33
    v_fmac_f32 v26, s61, v34
    v_fmac_f32 v27, s61, v35
    v_fmac_f32 v28, s61, v36
    v_fmac_f32 v29, s61, v37
    v_fmac_f32 v30, s61, v38
    v_fmac_f32 v31, s61, v39
    v_lshlrev_b32 v32, 16, v232
    v_and_b32 v33, 0xffff0000, v232
    v_lshlrev_b32 v34, 16, v233
    v_and_b32 v35, 0xffff0000, v233
    v_lshlrev_b32 v36, 16, v234
    v_and_b32 v37, 0xffff0000, v234
    v_lshlrev_b32 v38, 16, v235
    v_and_b32 v39, 0xffff0000, v235
    v_fmac_f32 v24, s62, v32
    v_fmac_f32 v25, s62, v33
    v_fmac_f32 v26, s62, v34
    v_fmac_f32 v27, s62, v35
    v_fmac_f32 v28, s62, v36
    v_fmac_f32 v29, s62, v37
    v_fmac_f32 v30, s62, v38
    v_fmac_f32 v31, s62, v39
    v_lshlrev_b32 v32, 16, v236
    v_and_b32 v33, 0xffff0000, v236
    v_lshlrev_b32 v34, 16, v237
    v_and_b32 v35, 0xffff0000, v237
    v_lshlrev_b32 v36, 16, v238
    v_and_b32 v37, 0xffff0000, v238
    v_lshlrev_b32 v38, 16, v239
    v_and_b32 v39, 0xffff0000, v239
    v_fmac_f32 v24, s63, v32
    v_fmac_f32 v25, s63, v33
    v_fmac_f32 v26, s63, v34
    v_fmac_f32 v27, s63, v35
    v_fmac_f32 v28, s63, v36
    v_fmac_f32 v29, s63, v37
    v_fmac_f32 v30, s63, v38
    v_fmac_f32 v31, s63, v39
    v_lshlrev_b32 v32, 16, v240
    v_and_b32 v33, 0xffff0000, v240
    v_lshlrev_b32 v34, 16, v241
    v_and_b32 v35, 0xffff0000, v241
    v_lshlrev_b32 v36, 16, v242
    v_and_b32 v37, 0xffff0000, v242
    v_lshlrev_b32 v38, 16, v243
    v_and_b32 v39, 0xffff0000, v243
    v_fmac_f32 v24, s64, v32
    v_fmac_f32 v25, s64, v33
    v_fmac_f32 v26, s64, v34
    v_fmac_f32 v27, s64, v35
    v_fmac_f32 v28, s64, v36
    v_fmac_f32 v29, s64, v37
    v_fmac_f32 v30, s64, v38
    v_fmac_f32 v31, s64, v39
    v_lshlrev_b32 v32, 16, v244
    v_and_b32 v33, 0xffff0000, v244
    v_lshlrev_b32 v34, 16, v245
    v_and_b32 v35, 0xffff0000, v245
    v_lshlrev_b32 v36, 16, v246
    v_and_b32 v37, 0xffff0000, v246
    v_lshlrev_b32 v38, 16, v247
    v_and_b32 v39, 0xffff0000, v247
    v_fmac_f32 v24, s65, v32
    v_fmac_f32 v25, s65, v33
    v_fmac_f32 v26, s65, v34
    v_fmac_f32 v27, s65, v35
    v_fmac_f32 v28, s65, v36
    v_fmac_f32 v29, s65, v37
    v_fmac_f32 v30, s65, v38
    v_fmac_f32 v31, s65, v39
    v_lshlrev_b32 v32, 16, v248
    v_and_b32 v33, 0xffff0000, v248
    v_lshlrev_b32 v34, 16, v249
    v_and_b32 v35, 0xffff0000, v249
    v_lshlrev_b32 v36, 16, v250
    v_and_b32 v37, 0xffff0000, v250
    v_lshlrev_b32 v38, 16, v251
    v_and_b32 v39, 0xffff0000, v251
    v_fmac_f32 v24, s66, v32
    v_fmac_f32 v25, s66, v33
    v_fmac_f32 v26, s66, v34
    v_fmac_f32 v27, s66, v35
    v_fmac_f32 v28, s66, v36
    v_fmac_f32 v29, s66, v37
    v_fmac_f32 v30, s66, v38
    v_fmac_f32 v31, s66, v39
    v_lshlrev_b32 v32, 16, v252
    v_and_b32 v33, 0xffff0000, v252
    v_lshlrev_b32 v34, 16, v253
    v_and_b32 v35, 0xffff0000, v253
    v_lshlrev_b32 v36, 16, v254
    v_and_b32 v37, 0xffff0000, v254
    v_lshlrev_b32 v38, 16, v255
    v_and_b32 v39, 0xffff0000, v255
    v_fmac_f32 v24, s67, v32
    v_fmac_f32 v25, s67, v33
    v_fmac_f32 v26, s67, v34
    v_fmac_f32 v27, s67, v35
    v_fmac_f32 v28, s67, v36
    v_fmac_f32 v29, s67, v37
    v_fmac_f32 v30, s67, v38
    v_fmac_f32 v31, s67, v39
    s_barrier
    v_lshlrev_b32 v5, 5, v1
    s_lshl_b32 s30, s26, 11
    v_add_u32 v5, s30, v5
    ds_write_b128 v5, v[24:27]
    ds_write_b128 v5, v[28:31] offset:16
    s_waitcnt lgkmcnt(0)
    s_barrier
    v_lshlrev_b32 v5, 3, v0
    ds_read_b64 v[8:9], v5 offset:0
    ds_read_b64 v[10:11], v5 offset:2048
    ds_read_b64 v[12:13], v5 offset:4096
    ds_read_b64 v[14:15], v5 offset:6144
    s_waitcnt lgkmcnt(0)
    v_add_f32 v8, v8, v10
    v_add_f32 v9, v9, v11
    v_add_f32 v12, v12, v14
    v_add_f32 v13, v13, v15
    v_add_f32 v8, v8, v12
    v_add_f32 v9, v9, v13
    s_lshl_b32 s28, s56, 19
    s_lshl_b32 s29, s55, 18
    s_add_u32 s28, s28, s29
    s_lshl_b32 s29, s54, 13
    s_add_u32 s28, s28, s29
    s_lshl_b32 s29, s52, 11
    s_add_u32 s28, s28, s29
    s_add_u32 s28, s28, 10485760
    v_or_b32 v8, 1, v8
    v_or_b32 v9, 1, v9
    buffer_store_dwordx2 v[8:9], v5, s[20:23], s28 offen sc1
    s_branch K3_END
K3_RED:
    s_load_dwordx2 s[20:21], s[0:1], 104
    s_load_dwordx2 s[8:9], s[0:1], 88
    s_sub_u32 s3, s2, 512
    s_lshr_b32 s24, s3, 3
    s_and_b32 s25, s3, 7
    v_and_b32 v1, 15, v0
    v_lshrrev_b32 v2, 4, v0
    v_lshlrev_b32 v3, 14, v2
    v_lshl_add_u32 v3, v1, 4, v3
    s_lshl_b32 s26, s24, 18
    s_lshl_b32 s27, s25, 8
    s_add_u32 s26, s26, s27
    s_add_u32 s26, s26, 10485760
    s_mov_b32 s30, 0x80000
    s_waitcnt lgkmcnt(0)
    s_mov_b32 s22, 536870912
    s_mov_b32 s23, 0x20000
    s_mov_b32 s10, 4096
    s_mov_b32 s11, 0x20000
K3_RLOOP:
    s_mov_b32 s27, s26
    buffer_load_dwordx4 v[8:11], v3, s[20:23], s27 offen offset:0 sc1
    buffer_load_dwordx4 v[12:15], v3, s[20:23], s27 offen offset:2048 sc1
    s_add_u32 s27, s27, 4096
    buffer_load_dwordx4 v[16:19], v3, s[20:23], s27 offen offset:0 sc1
    buffer_load_dwordx4 v[20:23], v3, s[20:23], s27 offen offset:2048 sc1
    s_add_u32 s27, s27, 4096
    buffer_load_dwordx4 v[24:27], v3, s[20:23], s27 offen offset:0 sc1
    buffer_load_dwordx4 v[28:31], v3, s[20:23], s27 offen offset:2048 sc1
    s_add_u32 s27, s27, 4096
    buffer_load_dwordx4 v[32:35], v3, s[20:23], s27 offen offset:0 sc1
    buffer_load_dwordx4 v[36:39], v3, s[20:23], s27 offen offset:2048 sc1
    s_waitcnt vmcnt(0)
    v_and_b32 v40, v8, v9
    v_and_b32 v40, v40, v10
    v_and_b32 v40, v40, v11
    v_and_b32 v40, v40, v12
    v_and_b32 v40, v40, v13
    v_and_b32 v40, v40, v14
    v_and_b32 v40, v40, v15
    v_and_b32 v40, v40, v16
    v_and_b32 v40, v40, v17
    v_and_b32 v40, v40, v18
    v_and_b32 v40, v40, v19
    v_and_b32 v40, v40, v20
    v_and_b32 v40, v40, v21
    v_and_b32 v40, v40, v22
    v_and_b32 v40, v40, v23
    v_and_b32 v40, v40, v24
    v_and_b32 v40, v40, v25
    v_and_b32 v40, v40, v26
    v_and_b32 v40, v40, v27
    v_and_b32 v40, v40, v28
    v_and_b32 v40, v40, v29
    v_and_b32 v40, v40, v30
    v_and_b32 v40, v40, v31
    v_and_b32 v40, v40, v32
    v_and_b32 v40, v40, v33
    v_and_b32 v40, v40, v34
    v_and_b32 v40, v40, v35
    v_and_b32 v40, v40, v36
    v_and_b32 v40, v40, v37
    v_and_b32 v40, v40, v38
    v_and_b32 v40, v40, v39
    v_and_b32 v40, 1, v40
    v_cmp_eq_u32 vcc, 0, v40
    s_cbranch_vccz K3_ROK
    s_sleep 2
    s_sub_u32 s30, s30, 1
    s_cmp_lg_u32 s30, 0
    s_cbranch_scc1 K3_RLOOP
K3_ROK:
    v_add_f32 v8, v8, v24
    v_add_f32 v9, v9, v25
    v_add_f32 v10, v10, v26
    v_add_f32 v11, v11, v27
    v_add_f32 v12, v12, v28
    v_add_f32 v13, v13, v29
    v_add_f32 v14, v14, v30
    v_add_f32 v15, v15, v31
    v_add_f32 v16, v16, v32
    v_add_f32 v17, v17, v33
    v_add_f32 v18, v18, v34
    v_add_f32 v19, v19, v35
    v_add_f32 v20, v20, v36
    v_add_f32 v21, v21, v37
    v_add_f32 v22, v22, v38
    v_add_f32 v23, v23, v39
    v_add_f32 v8, v8, v16
    v_add_f32 v9, v9, v17
    v_add_f32 v10, v10, v18
    v_add_f32 v11, v11, v19
    v_add_f32 v12, v12, v20
    v_add_f32 v13, v13, v21
    v_add_f32 v14, v14, v22
    v_add_f32 v15, v15, v23
    v_add_f32 v8, v8, v12
    v_add_f32 v9, v9, v13
    v_add_f32 v10, v10, v14
    v_add_f32 v11, v11, v15
    v_lshlrev_b32 v4, 4, v0
    ds_write_b128 v4, v[8:11]
    s_waitcnt lgkmcnt(0)
    s_barrier
    v_cmp_gt_u32 vcc, 64, v0
    s_and_saveexec_b64 s[28:29], vcc
    s_cbranch_execz K3_END
    v_lshlrev_b32 v4, 2, v0
    ds_read_b32 v8, v4 offset:0
    ds_read_b32 v9, v4 offset:256
    ds_read_b32 v10, v4 offset:512
    ds_read_b32 v11, v4 offset:768
    ds_read_b32 v12, v4 offset:1024
    ds_read_b32 v13, v4 offset:1280
    ds_read_b32 v14, v4 offset:1536
    ds_read_b32 v15, v4 offset:1792
    ds_read_b32 v16, v4 offset:2048
    ds_read_b32 v17, v4 offset:2304
    ds_read_b32 v18, v4 offset:2560
    ds_read_b32 v19, v4 offset:2816
    ds_read_b32 v20, v4 offset:3072
    ds_read_b32 v21, v4 offset:3328
    ds_read_b32 v22, v4 offset:3584
    ds_read_b32 v23, v4 offset:3840
    s_waitcnt lgkmcnt(0)
    v_add_f32 v8, v8, v16
    v_add_f32 v9, v9, v17
    v_add_f32 v10, v10, v18
    v_add_f32 v11, v11, v19
    v_add_f32 v12, v12, v20
    v_add_f32 v13, v13, v21
    v_add_f32 v14, v14, v22
    v_add_f32 v15, v15, v23
    v_add_f32 v8, v8, v12
    v_add_f32 v9, v9, v13
    v_add_f32 v10, v10, v14
    v_add_f32 v11, v11, v15
    v_add_f32 v8, v8, v10
    v_add_f32 v9, v9, v11
    v_add_f32 v8, v8, v9
    v_cvt_pk_bf16_f32 v8, v8, v8
    s_and_b32 s26, s24, 1
    s_lshl_b32 s26, s26, 11
    s_lshr_b32 s27, s24, 1
    s_lshl_b32 s27, s27, 10
    s_add_u32 s26, s26, s27
    s_lshl_b32 s27, s25, 7
    s_add_u32 s26, s26, s27
    v_lshlrev_b32 v4, 1, v0
    buffer_store_short v8, v4, s[8:11], s26 offen
K3_END:
    s_endpgm
.section .rodata,"a"
.p2align 6
.amdhsa_kernel k0_kernel
  .amdhsa_next_free_vgpr 88
  .amdhsa_next_free_sgpr 102
  .amdhsa_accum_offset 88
  .amdhsa_group_segment_fixed_size 0
  .amdhsa_kernarg_size 112
  .amdhsa_user_sgpr_count 2
  .amdhsa_user_sgpr_kernarg_segment_ptr 1
  .amdhsa_system_sgpr_workgroup_id_x 1
.end_amdhsa_kernel
.p2align 6
.amdhsa_kernel km_kernel
  .amdhsa_next_free_vgpr 512
  .amdhsa_next_free_sgpr 102
  .amdhsa_accum_offset 256
  .amdhsa_group_segment_fixed_size 0
  .amdhsa_kernarg_size 112
  .amdhsa_user_sgpr_count 2
  .amdhsa_user_sgpr_kernarg_segment_ptr 1
  .amdhsa_system_sgpr_workgroup_id_x 1
.end_amdhsa_kernel
.p2align 6
.amdhsa_kernel k3_kernel
  .amdhsa_next_free_vgpr 256
  .amdhsa_next_free_sgpr 102
  .amdhsa_accum_offset 256
  .amdhsa_group_segment_fixed_size 0
  .amdhsa_kernarg_size 112
  .amdhsa_user_sgpr_count 2
  .amdhsa_user_sgpr_kernarg_segment_ptr 1
  .amdhsa_system_sgpr_workgroup_id_x 1
.end_amdhsa_kernel
```
